```python
import torch

def _softmax(x, axis=-1):
    return torch.softmax(x, dim=axis)
def _gelu(x):
    return torch.nn.functional.gelu(x, approximate="tanh")
def _silu(x):
    return torch.nn.functional.silu(x)
def _sigmoid(x):
    return torch.sigmoid(x)
def _layernorm(x, axis=-1, eps=1e-5):
    m = x.mean(dim=axis, keepdim=True)
    v = x.var(dim=axis, keepdim=True, unbiased=False)
    return (x - m) / torch.sqrt(v + eps)
def _scatter_add(tgt, idx, src, axis=0):
    return tgt.clone().index_add_(axis, idx, src)
def _segment_sum(src, seg, n):
    out = torch.zeros((n,) + src.shape[1:], dtype=src.dtype)
    return out.index_add_(0, seg, src)
def _pad(x, pw):
    flat = tuple(v for pair in reversed(pw) for v in pair)
    return torch.nn.functional.pad(x, flat)

kernel_name = 'standalone__detection_seg_mask2former__vision'

def setup_inputs():

    _w = (lambda a: (lambda t: t.to(torch.bfloat16) if t.is_floating_point() else t)(torch.as_tensor(a)))
    H = W = 384
    C = 96
    Hc, Wc = H // 2, W // 2
    nh = 4
    Nq = 16
    sc = C ** -0.5
    return {
        "q": _w((lambda *s: torch.randn(*s, dtype=torch.bfloat16) * 0.2)(1, Nq, C)),
        "f_hi": _w((lambda *s: torch.randn(*s, dtype=torch.bfloat16) * 0.2)(1, H, W, C)),
        "f_lo": _w((lambda *s: torch.randn(*s, dtype=torch.bfloat16) * 0.4)(1, Hc, Wc, C)),
        "w_lat": _w((lambda *s: torch.randn(*s, dtype=torch.bfloat16) * 0.4)(C, C) * sc),
        "w_q": _w((lambda *s: torch.randn(*s, dtype=torch.bfloat16) * 3.2)(nh, C, C // nh) * sc),
        "w_k": _w((lambda *s: torch.randn(*s, dtype=torch.bfloat16) * 3.2)(nh, C, C // nh) * sc),
        "w_v": _w((lambda *s: torch.randn(*s, dtype=torch.bfloat16) * 3.2)(nh, C, C // nh) * sc),
        "w_o": _w((lambda *s: torch.randn(*s, dtype=torch.bfloat16) * 3.2)(C, C) * sc),
        "w_m": _w((lambda *s: torch.randn(*s, dtype=torch.bfloat16) * 1.6)(C, C) * sc),
    }

def reference(q, f_hi, f_lo, w_lat, w_q, w_k, w_v, w_o, w_m):
    B, Nq, C = q.shape
    _, H, W, _ = f_hi.shape
    nh = w_q.shape[0]
    dh = C // nh
    up = (lambda x, n, axis: torch.repeat_interleave(x, n, dim=axis))((lambda x, n, axis: torch.repeat_interleave(x, n, dim=axis))(f_lo, 2, axis=1), 2, axis=2)
    feat = f_hi + up @ w_lat
    feat = _layernorm(feat, axis=-1)
    kv = feat.reshape(B, H * W, C)
    m_embed = q @ w_m
    mask_bias = torch.einsum('bqc,bkc->bqk', m_embed, kv) * (C ** -0.5)
    Q = torch.einsum('bqc,hcd->bhqd', q, w_q)
    K = torch.einsum('bkc,hcd->bhkd', kv, w_k)
    V = torch.einsum('bkc,hcd->bhkd', kv, w_v)
    logits = torch.einsum('bhqd,bhkd->bhqk', Q, K) * (dh ** -0.5)
    logits = logits + mask_bias[:, None, :, :]
    attn = _softmax(logits, axis=-1)
    ctx = torch.einsum('bhqk,bhkd->bqhd', attn, V).reshape(B, Nq, C)
    return q + ctx @ w_o
```

```asm
; @launch grid=(256,1,1) block=(512,1,1) lds=163840
.amdgcn_target "amdgcn-amd-amdhsa--gfx950"
.text
.globl standalone__detection_seg_mask2former__vision_kernel
.p2align 8
.type standalone__detection_seg_mask2former__vision_kernel,@function
standalone__detection_seg_mask2former__vision_kernel:
    s_cmp_ge_u32 s2, 256
    s_cbranch_scc1 L_end
    s_load_dwordx16 s[4:19], s[0:1], 0
    s_load_dwordx8 s[20:27], s[0:1], 64
    v_lshrrev_b32 v2, 6, v0
    v_and_b32 v1, 63, v0
    v_readfirstlane_b32 s3, v2
    s_mov_b32 s63, 0x5faaf50
    s_mov_b32 s62, 0x42c00000
    s_nop 1
    s_cmp_ge_u32 s3, 4
    s_cbranch_scc1 L_cons
    v_add_u32 v232, 0, v1
    v_mul_u32_u24 v232, 0xaaab, v232
    v_lshrrev_b32 v232, 18, v232
    v_and_b32 v9, 0x1e, v232
    v_bfe_u32 v232, s63, v9, 2
    v_xor_b32 v232, v232, v1
    v_lshlrev_b32 v2, 4, v232
    v_add_u32 v232, 64, v1
    v_mul_u32_u24 v232, 0xaaab, v232
    v_lshrrev_b32 v232, 18, v232
    v_and_b32 v10, 0x1e, v232
    v_bfe_u32 v232, s63, v10, 2
    v_xor_b32 v232, v232, v1
    v_lshlrev_b32 v3, 4, v232
    v_add_u32 v232, 128, v1
    v_mul_u32_u24 v232, 0xaaab, v232
    v_lshrrev_b32 v232, 18, v232
    v_and_b32 v11, 0x1e, v232
    v_bfe_u32 v232, s63, v11, 2
    v_xor_b32 v232, v232, v1
    v_lshlrev_b32 v4, 4, v232
    v_lshlrev_b32 v235, 4, v1
    v_mov_b32 v236, 0
    v_mov_b32 v237, 0
    v_mov_b32 v238, 0
    v_mov_b32 v239, 0
    v_add_u32 v240, 162816, v235
    ds_write_b128 v240, v[236:239]
    s_lshl_b32 s58, s2, 2
    s_add_u32 s58, s58, s3
    s_mul_i32 s43, s58, 6144
    s_mul_i32 s45, s3, 6144
    s_add_u32 s46, s45, 116736
    s_mov_b32 s34, 7077888
    s_mov_b32 s35, 0x20000
    s_add_u32 s60, s2, 2048
    s_mul_i32 s61, s60, 3072
    s_cmp_lt_u32 s3, 2
    s_cselect_b32 s55, s61, s43
    s_cselect_b32 s56, 141312, s46
    s_mov_b32 s30, 28311552
    s_mov_b32 s31, 0x20000
    s_min_u32 s52, s3, 2
    s_lshl_b32 s47, s3, 2
    s_add_u32 s47, s47, s52
    s_lshl_b32 s47, s47, 10
    v_add_u32 v15, s47, v235
    s_mul_i32 s52, s58, 43691
    s_lshr_b32 s52, s52, 18
    s_mul_i32 s52, s52, 73728
    s_mul_i32 s40, s58, 12288
    s_add_u32 s40, s40, s52
    s_mul_i32 s52, s60, 43691
    s_lshr_b32 s52, s52, 19
    s_add_u32 s52, s52, s3
    s_mul_i32 s52, s52, 73728
    s_mul_i32 s42, s60, 6144
    s_add_u32 s42, s42, s52
    s_cmp_lt_u32 s3, 2
    s_cselect_b32 s57, s42, s40
    s_cselect_b32 s44, 1, 0
    s_cselect_b32 s52, 0, 96
    s_lshr_b32 s41, 6144, s44
    s_cmp_lt_u32 s3, 2
    s_waitcnt lgkmcnt(0)
    s_mov_b32 s32, s8
    s_mov_b32 s33, s9
    s_cbranch_scc1 P_sm
    s_add_u32 m0, s56, 3072
    s_add_u32 s53, s55, 3072
    buffer_load_dwordx4 v2, s[32:35], s53 offen offset:0 nt lds
    buffer_load_dwordx4 v3, s[32:35], s53 offen offset:1024 nt lds
    buffer_load_dwordx4 v4, s[32:35], s53 offen offset:2048 nt lds
    s_branch P_nox
P_sm:
    s_add_u32 s50, s10, 4096
    s_addc_u32 s51, s11, 0
    s_add_u32 m0, s47, 148480
    s_nop 0
    global_load_lds_dwordx4 v15, s[50:51]
P_nox:
    s_add_u32 m0, s47, 144384
    s_nop 0
    global_load_lds_dwordx4 v15, s[10:11] offset:0
    global_load_lds_dwordx4 v15, s[10:11] offset:1024
    global_load_lds_dwordx4 v15, s[10:11] offset:2048
    global_load_lds_dwordx4 v15, s[10:11] offset:3072
    s_mov_b32 m0, s56
    s_mov_b32 s28, s6
    buffer_load_dwordx4 v2, s[32:35], s55 offen offset:0 nt lds
    buffer_load_dwordx4 v3, s[32:35], s55 offen offset:1024 nt lds
    buffer_load_dwordx4 v4, s[32:35], s55 offen offset:2048 nt lds
    s_mov_b32 s29, s7
    s_barrier
    v_mad_u32_u24 v244, v9, s52, v2
    v_mul_u32_u24 v9, 96, v9
    v_add_u32 v9, v9, v2
    v_mad_u32_u24 v245, v10, s52, v3
    v_mul_u32_u24 v10, 96, v10
    v_add_u32 v10, v10, v3
    v_mad_u32_u24 v246, v11, s52, v4
    v_mul_u32_u24 v11, 96, v11
    v_add_u32 v11, v11, v4
    v_and_b32 v232, 31, v1
    v_lshrrev_b32 v233, 5, v1
    v_lshlrev_b32 v234, 1, v232
    v_and_b32 v234, 0x1e, v234
    v_bfe_u32 v234, s63, v234, 2
    v_xor_b32 v234, v234, v233
    v_xor_b32 v235, 2, v234
    v_mul_u32_u24 v236, 192, v232
    v_add_u32 v236, s45, v236
    v_lshl_add_u32 v5, v234, 4, v236
    v_lshl_add_u32 v6, v235, 4, v236
    v_lshrrev_b32 v237, s44, v232
    v_lshlrev_b32 v234, 1, v237
    v_and_b32 v234, 0x1e, v234
    v_bfe_u32 v234, s63, v234, 2
    v_xor_b32 v234, v234, v233
    v_xor_b32 v235, 2, v234
    v_mul_u32_u24 v236, 192, v237
    v_add_u32 v236, s56, v236
    v_lshl_add_u32 v7, v234, 4, v236
    v_lshl_add_u32 v8, v235, 4, v236
    v_bfe_u32 v14, v1, 2, 2
    v_lshl_add_u32 v14, v233, 3, v14
    v_mul_u32_u24 v14, 192, v14
    v_bfe_u32 v240, v1, 4, 1
    v_lshl_add_u32 v14, v240, 5, v14
    v_and_b32 v235, 1, v1
    v_lshl_add_u32 v14, v235, 4, v14
    v_bfe_u32 v235, v1, 1, 1
    v_lshl_add_u32 v14, v235, 3, v14
    v_add_u32 v14, 144384, v14
    v_bfe_u32 v234, v1, 3, 1
    v_and_b32 v235, 3, v1
    v_lshl_add_u32 v234, v234, 2, v235
    v_bfe_u32 v235, v1, 2, 1
    v_cmp_eq_u32 vcc, v235, v233
    v_and_b32 v238, 1, v234
    v_lshlrev_b32 v238, 4, v238
    v_mov_b32 v236, 0x3f80
    v_lshlrev_b32 v238, v238, v236
    v_cndmask_b32 v238, 0, v238, vcc
    v_lshrrev_b32 v234, 1, v234
    v_lshl_add_u32 v234, v240, 2, v234
    v_cmp_eq_u32 s[58:59], v235, v240
    v_mov_b32 v239, 0x3f803f80
    v_cmp_eq_u32 vcc, 0, v234
    v_cmp_eq_u32 s[60:61], 1, v234
    v_cndmask_b32 v216, 0, v239, s[58:59]
    v_cndmask_b32 v208, 0, v238, vcc
    v_cndmask_b32 v209, 0, v238, s[60:61]
    v_cmp_eq_u32 vcc, 2, v234
    v_cmp_eq_u32 s[60:61], 3, v234
    v_cndmask_b32 v217, 0, v239, s[58:59]
    v_cndmask_b32 v210, 0, v238, vcc
    v_cndmask_b32 v211, 0, v238, s[60:61]
    v_cmp_eq_u32 vcc, 4, v234
    v_cmp_eq_u32 s[60:61], 5, v234
    v_cndmask_b32 v218, 0, v239, s[58:59]
    v_cndmask_b32 v212, 0, v238, vcc
    v_cndmask_b32 v213, 0, v238, s[60:61]
    v_cmp_eq_u32 vcc, 6, v234
    v_cmp_eq_u32 s[60:61], 7, v234
    v_cndmask_b32 v219, 0, v239, s[58:59]
    v_cndmask_b32 v214, 0, v238, vcc
    v_cndmask_b32 v215, 0, v238, s[60:61]
    s_waitcnt vmcnt(0)
    v_mov_b32 v12, 163360
    v_mov_b32 v13, 1
    s_mov_b64 exec, 1
    ds_add_u32 v12, v13
    s_mov_b64 exec, -1
    s_lshr_b32 s52, s3, 1
    s_lshl_b32 s52, s52, 2
    s_add_u32 s52, s52, 163380
    v_mov_b32 v15, s52
P_sy5:
    ds_read_b32 v13, v15
    s_waitcnt lgkmcnt(0)
    v_readfirstlane_b32 s50, v13
    s_nop 3
    s_cmp_lt_u32 s50, 4
    s_cbranch_scc1 P_sy5
    s_cmp_lt_u32 s3, 2
    s_cbranch_scc1 P_f1
    s_add_u32 m0, s45, 0
    s_nop 0
    buffer_load_dwordx4 v9, s[28:31], s40 offen offset:0 nt lds
    buffer_load_dwordx4 v10, s[28:31], s40 offen offset:1024 nt lds
    buffer_load_dwordx4 v11, s[28:31], s40 offen offset:2048 nt lds
    s_add_u32 m0, s45, 24576
    s_add_u32 s52, s40, 192
    buffer_load_dwordx4 v9, s[28:31], s52 offen offset:0 nt lds
    buffer_load_dwordx4 v10, s[28:31], s52 offen offset:1024 nt lds
    buffer_load_dwordx4 v11, s[28:31], s52 offen offset:2048 nt lds
    s_add_u32 m0, s45, 3072
    s_add_u32 s52, s40, 6144
    buffer_load_dwordx4 v9, s[28:31], s52 offen offset:0 nt lds
    buffer_load_dwordx4 v10, s[28:31], s52 offen offset:1024 nt lds
    buffer_load_dwordx4 v11, s[28:31], s52 offen offset:2048 nt lds
    s_add_u32 m0, s45, 27648
    s_add_u32 s52, s40, 6336
    buffer_load_dwordx4 v9, s[28:31], s52 offen offset:0 nt lds
    buffer_load_dwordx4 v10, s[28:31], s52 offen offset:1024 nt lds
    buffer_load_dwordx4 v11, s[28:31], s52 offen offset:2048 nt lds
    s_branch P_f2
P_f1:
    s_add_u32 m0, s45, 0
    s_nop 0
    buffer_load_dwordx4 v244, s[28:31], s57 offen offset:0 nt lds
    buffer_load_dwordx4 v245, s[28:31], s57 offen offset:1024 nt lds
    buffer_load_dwordx4 v246, s[28:31], s57 offen offset:2048 nt lds
    s_add_u32 m0, s45, 3072
    s_add_u32 s52, s57, s41
    buffer_load_dwordx4 v244, s[28:31], s52 offen offset:0 nt lds
    buffer_load_dwordx4 v245, s[28:31], s52 offen offset:1024 nt lds
    buffer_load_dwordx4 v246, s[28:31], s52 offen offset:2048 nt lds
P_f2:
    ds_read_b128 v[136:139], v7 offset:0
    ds_read_b128 v[140:143], v8 offset:0
    ds_read_b128 v[144:147], v7 offset:64
    ds_read_b128 v[148:151], v8 offset:64
    ds_read_b128 v[152:155], v7 offset:128
    ds_read_b128 v[156:159], v8 offset:128
P_sy0:
    ds_read_b32 v13, v12
    s_waitcnt lgkmcnt(0)
    v_readfirstlane_b32 s50, v13
    s_nop 3
    s_cmp_lt_u32 s50, 4
    s_cbranch_scc1 P_sy0
    ds_read_b64_tr_b16 v[16:17], v14 offset:0
    ds_read_b64_tr_b16 v[18:19], v14 offset:768
    ds_read_b64_tr_b16 v[20:21], v14 offset:3072
    ds_read_b64_tr_b16 v[22:23], v14 offset:3840
    ds_read_b64_tr_b16 v[24:25], v14 offset:6144
    ds_read_b64_tr_b16 v[26:27], v14 offset:6912
    ds_read_b64_tr_b16 v[28:29], v14 offset:9216
    ds_read_b64_tr_b16 v[30:31], v14 offset:9984
    s_waitcnt lgkmcnt(6)
    v_mfma_f32_32x32x16_bf16 v[88:103], v[16:19], v[136:139], 0
    ds_read_b64_tr_b16 v[32:33], v14 offset:12288
    ds_read_b64_tr_b16 v[34:35], v14 offset:13056
    s_waitcnt lgkmcnt(6)
    v_mfma_f32_32x32x16_bf16 v[88:103], v[20:23], v[140:143], v[88:103]
    ds_read_b64_tr_b16 v[36:37], v14 offset:15360
    ds_read_b64_tr_b16 v[38:39], v14 offset:16128
    s_waitcnt lgkmcnt(6)
    v_mfma_f32_32x32x16_bf16 v[88:103], v[24:27], v[144:147], v[88:103]
    ds_read_b64_tr_b16 v[40:41], v14 offset:64
    ds_read_b64_tr_b16 v[42:43], v14 offset:832
    s_waitcnt lgkmcnt(6)
    v_mfma_f32_32x32x16_bf16 v[88:103], v[28:31], v[148:151], v[88:103]
    ds_read_b64_tr_b16 v[44:45], v14 offset:3136
    ds_read_b64_tr_b16 v[46:47], v14 offset:3904
    s_waitcnt lgkmcnt(6)
    v_mfma_f32_32x32x16_bf16 v[88:103], v[32:35], v[152:155], v[88:103]
    ds_read_b64_tr_b16 v[48:49], v14 offset:6208
    ds_read_b64_tr_b16 v[50:51], v14 offset:6976
    s_waitcnt lgkmcnt(6)
    v_mfma_f32_32x32x16_bf16 v[88:103], v[36:39], v[156:159], v[88:103]
    ds_read_b64_tr_b16 v[52:53], v14 offset:9280
    ds_read_b64_tr_b16 v[54:55], v14 offset:10048
    s_waitcnt lgkmcnt(6)
    v_mfma_f32_32x32x16_bf16 v[104:119], v[40:43], v[136:139], 0
    ds_read_b64_tr_b16 v[56:57], v14 offset:12352
    ds_read_b64_tr_b16 v[58:59], v14 offset:13120
    s_waitcnt lgkmcnt(6)
    v_mfma_f32_32x32x16_bf16 v[104:119], v[44:47], v[140:143], v[104:119]
    ds_read_b64_tr_b16 v[60:61], v14 offset:15424
    ds_read_b64_tr_b16 v[62:63], v14 offset:16192
    v_mov_b32 v224, v88
    v_add_f32 v224, v224, v89
    v_add_f32 v224, v224, v90
    v_add_f32 v224, v224, v91
    s_waitcnt lgkmcnt(6)
    v_mfma_f32_32x32x16_bf16 v[104:119], v[48:51], v[144:147], v[104:119]
    ds_read_b64_tr_b16 v[64:65], v14 offset:128
    ds_read_b64_tr_b16 v[66:67], v14 offset:896
    v_add_f32 v224, v224, v92
    v_add_f32 v224, v224, v93
    v_add_f32 v224, v224, v94
    v_add_f32 v224, v224, v95
    s_waitcnt lgkmcnt(6)
    v_mfma_f32_32x32x16_bf16 v[104:119], v[52:55], v[148:151], v[104:119]
    ds_read_b64_tr_b16 v[68:69], v14 offset:3200
    ds_read_b64_tr_b16 v[70:71], v14 offset:3968
    v_add_f32 v224, v224, v96
    v_add_f32 v224, v224, v97
    v_add_f32 v224, v224, v98
    v_add_f32 v224, v224, v99
    s_waitcnt lgkmcnt(6)
    v_mfma_f32_32x32x16_bf16 v[104:119], v[56:59], v[152:155], v[104:119]
    ds_read_b64_tr_b16 v[72:73], v14 offset:6272
    ds_read_b64_tr_b16 v[74:75], v14 offset:7040
    v_add_f32 v224, v224, v100
    v_add_f32 v224, v224, v101
    v_add_f32 v224, v224, v102
    v_add_f32 v224, v224, v103
    s_waitcnt lgkmcnt(6)
    v_mfma_f32_32x32x16_bf16 v[104:119], v[60:63], v[156:159], v[104:119]
    ds_read_b64_tr_b16 v[76:77], v14 offset:9344
    ds_read_b64_tr_b16 v[78:79], v14 offset:10112
    s_waitcnt lgkmcnt(6)
    v_mfma_f32_32x32x16_bf16 v[120:135], v[64:67], v[136:139], 0
    ds_read_b64_tr_b16 v[80:81], v14 offset:12416
    ds_read_b64_tr_b16 v[82:83], v14 offset:13184
    s_waitcnt lgkmcnt(6)
    v_mfma_f32_32x32x16_bf16 v[120:135], v[68:71], v[140:143], v[120:135]
    ds_read_b64_tr_b16 v[84:85], v14 offset:15488
    ds_read_b64_tr_b16 v[86:87], v14 offset:16256
    v_add_f32 v224, v224, v104
    v_add_f32 v224, v224, v105
    v_add_f32 v224, v224, v106
    v_add_f32 v224, v224, v107
    s_waitcnt lgkmcnt(6)
    v_mfma_f32_32x32x16_bf16 v[120:135], v[72:75], v[144:147], v[120:135]
    v_add_f32 v224, v224, v108
    v_add_f32 v224, v224, v109
    v_add_f32 v224, v224, v110
    v_add_f32 v224, v224, v111
    s_waitcnt lgkmcnt(4)
    v_mfma_f32_32x32x16_bf16 v[120:135], v[76:79], v[148:151], v[120:135]
    v_add_f32 v224, v224, v112
    v_add_f32 v224, v224, v113
    v_add_f32 v224, v224, v114
    v_add_f32 v224, v224, v115
    s_waitcnt lgkmcnt(2)
    v_mfma_f32_32x32x16_bf16 v[120:135], v[80:83], v[152:155], v[120:135]
    v_add_f32 v224, v224, v116
    v_add_f32 v224, v224, v117
    v_add_f32 v224, v224, v118
    v_add_f32 v224, v224, v119
    s_waitcnt lgkmcnt(0)
    v_mfma_f32_32x32x16_bf16 v[120:135], v[84:87], v[156:159], v[120:135]
    s_nop 11
    v_add_f32 v224, v224, v120
    v_add_f32 v224, v224, v121
    v_add_f32 v224, v224, v122
    v_add_f32 v224, v224, v123
    v_add_f32 v224, v224, v124
    v_add_f32 v224, v224, v125
    v_add_f32 v224, v224, v126
    v_add_f32 v224, v224, v127
    v_add_f32 v224, v224, v128
    v_add_f32 v224, v224, v129
    v_add_f32 v224, v224, v130
    v_add_f32 v224, v224, v131
    v_add_f32 v224, v224, v132
    v_add_f32 v224, v224, v133
    v_add_f32 v224, v224, v134
    v_add_f32 v224, v224, v135
    v_mov_b32 v225, v224
    s_nop 1
    v_permlane32_swap_b32 v224, v225
    v_add_f32 v224, v224, v225
    v_mov_b32 v12, 163424
    v_mov_b32 v13, 1
    s_mov_b64 exec, 1
    ds_add_u32 v12, v13
    s_mov_b64 exec, -1
    s_lshl_b32 s52, s3, 2
    s_add_u32 s52, s52, 163328
    v_mov_b32 v14, s52
    v_mov_b32 v15, 0
    s_mov_b32 s61, 0x3dbcbe62
    v_mov_b32 v12, 163384
P_sy6:
    ds_read_b32 v13, v12
    s_waitcnt lgkmcnt(0)
    v_readfirstlane_b32 s50, v13
    s_nop 3
    s_cmp_lt_u32 s50, 4
    s_cbranch_scc1 P_sy6
    s_cmp_lt_u32 s3, 2
    s_cbranch_scc0 P_scriptB
    s_add_u32 m0, s46, 0
    s_add_u32 s52, s43, 0
    buffer_load_dwordx4 v2, s[32:35], s52 offen offset:0 nt lds
    buffer_load_dwordx4 v3, s[32:35], s52 offen offset:1024 nt lds
    buffer_load_dwordx4 v4, s[32:35], s52 offen offset:2048 nt lds
    s_add_u32 m0, s46, 3072
    s_add_u32 s52, s43, 3072
    buffer_load_dwordx4 v2, s[32:35], s52 offen offset:0 nt lds
    buffer_load_dwordx4 v3, s[32:35], s52 offen offset:1024 nt lds
    buffer_load_dwordx4 v4, s[32:35], s52 offen offset:2048 nt lds
    s_waitcnt vmcnt(6)
    s_call_b64 s[48:49], P_h0
    s_add_u32 m0, s45, 24576
    s_nop 0
    buffer_load_dwordx4 v9, s[28:31], s40 offen offset:0 nt lds
    buffer_load_dwordx4 v10, s[28:31], s40 offen offset:1024 nt lds
    buffer_load_dwordx4 v11, s[28:31], s40 offen offset:2048 nt lds
    s_add_u32 m0, s45, 49152
    s_add_u32 s52, s40, 192
    buffer_load_dwordx4 v9, s[28:31], s52 offen offset:0 nt lds
    buffer_load_dwordx4 v10, s[28:31], s52 offen offset:1024 nt lds
    buffer_load_dwordx4 v11, s[28:31], s52 offen offset:2048 nt lds
    s_add_u32 m0, s45, 27648
    s_add_u32 s52, s40, 6144
    buffer_load_dwordx4 v9, s[28:31], s52 offen offset:0 nt lds
    buffer_load_dwordx4 v10, s[28:31], s52 offen offset:1024 nt lds
    buffer_load_dwordx4 v11, s[28:31], s52 offen offset:2048 nt lds
    s_add_u32 m0, s45, 52224
    s_add_u32 s52, s40, 6336
    buffer_load_dwordx4 v9, s[28:31], s52 offen offset:0 nt lds
    buffer_load_dwordx4 v10, s[28:31], s52 offen offset:1024 nt lds
    buffer_load_dwordx4 v11, s[28:31], s52 offen offset:2048 nt lds
    s_waitcnt vmcnt(12)
    v_add_u32 v12, 92160, v5
    v_add_u32 v13, 92160, v6
    s_call_b64 s[48:49], P_lat
    s_waitcnt vmcnt(3)
    s_call_b64 s[48:49], P_h0
    v_mov_b32 v12, 163376
P_wa4:
    ds_read_b32 v13, v12
    s_waitcnt lgkmcnt(0)
    v_readfirstlane_b32 s50, v13
    s_nop 3
    s_cmp_lt_u32 s50, 4
    s_cbranch_scc1 P_wa4
    s_add_u32 s55, s45, 73728
    s_add_u32 s56, s40, 73728
    s_add_u32 s58, s45, 76800
    s_add_u32 s59, s40, 79872
    s_waitcnt vmcnt(0)
    s_call_b64 s[48:49], P_h4
    s_waitcnt vmcnt(3)
    s_call_b64 s[48:49], P_h0
    s_call_b64 s[48:49], P_h0w
    s_branch P_fin
P_scriptB:
    s_waitcnt vmcnt(3)
    s_call_b64 s[48:49], P_h0
    v_mov_b32 v12, 163376
P_wb3:
    ds_read_b32 v13, v12
    s_waitcnt lgkmcnt(0)
    v_readfirstlane_b32 s50, v13
    s_nop 3
    s_cmp_lt_u32 s50, 4
    s_cbranch_scc1 P_wb3
    s_add_u32 s55, s45, 49152
    s_add_u32 s56, s40, 73728
    s_add_u32 s58, s45, 52224
    s_add_u32 s59, s40, 79872
    s_waitcnt vmcnt(0)
    s_call_b64 s[48:49], P_h4
    s_waitcnt vmcnt(3)
    s_call_b64 s[48:49], P_h0
    v_mov_b32 v12, 163424
P_wl:
    ds_read_b32 v13, v12
    s_waitcnt lgkmcnt(0)
    v_readfirstlane_b32 s50, v13
    s_nop 3
    s_cmp_lt_u32 s50, 4
    s_cbranch_scc1 P_wl
    s_sub_u32 s52, s3, 2
    s_mul_i32 s52, s52, 9216
    v_lshlrev_b32 v12, 4, v1
    v_add_u32 v12, s52, v12
    s_add_u32 m0, s52, 144384
    s_add_u32 s50, s16, 0
    s_addc_u32 s51, s17, 0
    global_load_lds_dwordx4 v12, s[50:51] offset:0
    global_load_lds_dwordx4 v12, s[50:51] offset:1024
    global_load_lds_dwordx4 v12, s[50:51] offset:2048
    s_add_u32 m0, s52, 147456
    s_add_u32 s50, s16, 3072
    s_addc_u32 s51, s17, 0
    global_load_lds_dwordx4 v12, s[50:51] offset:0
    global_load_lds_dwordx4 v12, s[50:51] offset:1024
    global_load_lds_dwordx4 v12, s[50:51] offset:2048
    s_add_u32 m0, s52, 150528
    s_add_u32 s50, s16, 6144
    s_addc_u32 s51, s17, 0
    global_load_lds_dwordx4 v12, s[50:51] offset:0
    global_load_lds_dwordx4 v12, s[50:51] offset:1024
    global_load_lds_dwordx4 v12, s[50:51] offset:2048
    s_mov_b32 s36, s26
    s_mov_b32 s37, s27
    s_mov_b32 s38, 1310720
    s_mov_b32 s39, 0x20000
    v_and_b32 v12, 15, v1
    v_lshlrev_b32 v12, 16, v12
    v_lshrrev_b32 v13, 4, v1
    v_lshl_add_u32 v12, v13, 6, v12
    s_lshl_b32 s52, s2, 8
    buffer_load_dword v232, v12, s[36:39], s52 offen sc1
    v_mov_b32 v12, 0
    global_load_dword v234, v12, s[22:23]
    global_load_dword v233, v12, s[4:5]
    s_waitcnt vmcnt(12)
    s_call_b64 s[48:49], P_h0
    v_mov_b32 v15, 5
    s_waitcnt vmcnt(0)
    ds_write_b32 v14, v15
    s_cmp_ge_u32 s2, 16
    s_cbranch_scc1 L_exit
    v_mov_b32 v12, 163408
P_w17:
    ds_read_b128 v[232:235], v12
    s_waitcnt lgkmcnt(0)
    v_min_u32 v232, v232, v233
    v_min3_u32 v232, v232, v234, v235
    v_cmp_gt_u32 vcc, 24576, v232
    s_cbranch_vccnz P_w17
    s_sub_u32 s52, s3, 2
    s_mul_i32 s52, s52, 9216
    v_lshlrev_b32 v12, 4, v1
    v_add_u32 v12, s52, v12
    s_add_u32 m0, s52, 0
    s_add_u32 s50, s18, 0
    s_addc_u32 s51, s19, 0
    global_load_lds_dwordx4 v12, s[50:51] offset:0
    global_load_lds_dwordx4 v12, s[50:51] offset:1024
    global_load_lds_dwordx4 v12, s[50:51] offset:2048
    s_add_u32 m0, s52, 3072
    s_add_u32 s50, s18, 3072
    s_addc_u32 s51, s19, 0
    global_load_lds_dwordx4 v12, s[50:51] offset:0
    global_load_lds_dwordx4 v12, s[50:51] offset:1024
    global_load_lds_dwordx4 v12, s[50:51] offset:2048
    s_add_u32 m0, s52, 6144
    s_add_u32 s50, s18, 6144
    s_addc_u32 s51, s19, 0
    global_load_lds_dwordx4 v12, s[50:51] offset:0
    global_load_lds_dwordx4 v12, s[50:51] offset:1024
    global_load_lds_dwordx4 v12, s[50:51] offset:2048
P_fin:
    s_cmp_ge_u32 s2, 16
    s_cbranch_scc1 L_exit
    s_setprio 0
    s_load_dword s47, s[24:25], 0
    s_waitcnt lgkmcnt(0)
    s_cmp_eq_u32 s47, 0
    s_cbranch_scc1 P_getnonce
P_getnonce_d:
    s_mov_b32 s36, s26
    s_mov_b32 s37, s27
    s_mov_b32 s38, 1310720
    s_mov_b32 s39, 0x20000
    v_mov_b32 v12, 163388
P_w7:
    ds_read_b32 v13, v12
    s_waitcnt lgkmcnt(0)
    v_readfirstlane_b32 s50, v13
    s_nop 3
    s_cmp_lt_u32 s50, 4
    s_cbranch_scc1 P_w7
    s_cmp_lt_u32 s50, 0x100
    s_cbranch_scc1 L_comb
    s_branch Z_comb
P_getnonce:
    s_memrealtime s[50:51]
    s_waitcnt lgkmcnt(0)
    s_or_b32 s47, s50, 1
    v_mov_b32 v20, s47
    v_mov_b32 v21, 0
    v_mov_b32 v22, 0
    s_mov_b64 exec, 1
    global_atomic_cmpswap v20, v22, v[20:21], s[24:25] sc0 sc1
    s_mov_b64 exec, -1
    s_waitcnt vmcnt(0)
    v_readfirstlane_b32 s50, v20
    s_nop 3
    s_cmp_eq_u32 s50, 0
    s_cselect_b32 s47, s47, s50
    s_branch P_getnonce_d
P_lat:
    ds_read_b128 v[136:139], v12 offset:0
    ds_read_b128 v[140:143], v13 offset:0
    ds_read_b128 v[144:147], v12 offset:64
    ds_read_b128 v[148:151], v13 offset:64
    ds_read_b128 v[152:155], v12 offset:128
    ds_read_b128 v[156:159], v13 offset:128
    s_waitcnt lgkmcnt(5)
    v_mfma_f32_32x32x16_bf16 v[88:103], v[16:19], v[136:139], 0
    s_waitcnt lgkmcnt(4)
    v_mfma_f32_32x32x16_bf16 v[88:103], v[20:23], v[140:143], v[88:103]
    s_waitcnt lgkmcnt(3)
    v_mfma_f32_32x32x16_bf16 v[88:103], v[24:27], v[144:147], v[88:103]
    s_waitcnt lgkmcnt(2)
    v_mfma_f32_32x32x16_bf16 v[88:103], v[28:31], v[148:151], v[88:103]
    s_waitcnt lgkmcnt(1)
    v_mfma_f32_32x32x16_bf16 v[88:103], v[32:35], v[152:155], v[88:103]
    s_waitcnt lgkmcnt(0)
    v_mfma_f32_32x32x16_bf16 v[88:103], v[36:39], v[156:159], v[88:103]
    v_mfma_f32_32x32x16_bf16 v[104:119], v[40:43], v[136:139], 0
    v_mfma_f32_32x32x16_bf16 v[104:119], v[44:47], v[140:143], v[104:119]
    v_mov_b32 v224, v88
    v_add_f32 v224, v224, v89
    v_add_f32 v224, v224, v90
    v_add_f32 v224, v224, v91
    v_mfma_f32_32x32x16_bf16 v[104:119], v[48:51], v[144:147], v[104:119]
    v_add_f32 v224, v224, v92
    v_add_f32 v224, v224, v93
    v_add_f32 v224, v224, v94
    v_add_f32 v224, v224, v95
    v_mfma_f32_32x32x16_bf16 v[104:119], v[52:55], v[148:151], v[104:119]
    v_add_f32 v224, v224, v96
    v_add_f32 v224, v224, v97
    v_add_f32 v224, v224, v98
    v_add_f32 v224, v224, v99
    v_mfma_f32_32x32x16_bf16 v[104:119], v[56:59], v[152:155], v[104:119]
    v_add_f32 v224, v224, v100
    v_add_f32 v224, v224, v101
    v_add_f32 v224, v224, v102
    v_add_f32 v224, v224, v103
    v_mfma_f32_32x32x16_bf16 v[104:119], v[60:63], v[156:159], v[104:119]
    v_mfma_f32_32x32x16_bf16 v[120:135], v[64:67], v[136:139], 0
    v_mfma_f32_32x32x16_bf16 v[120:135], v[68:71], v[140:143], v[120:135]
    v_add_f32 v224, v224, v104
    v_add_f32 v224, v224, v105
    v_add_f32 v224, v224, v106
    v_add_f32 v224, v224, v107
    v_mfma_f32_32x32x16_bf16 v[120:135], v[72:75], v[144:147], v[120:135]
    v_add_f32 v224, v224, v108
    v_add_f32 v224, v224, v109
    v_add_f32 v224, v224, v110
    v_add_f32 v224, v224, v111
    v_mfma_f32_32x32x16_bf16 v[120:135], v[76:79], v[148:151], v[120:135]
    v_add_f32 v224, v224, v112
    v_add_f32 v224, v224, v113
    v_add_f32 v224, v224, v114
    v_add_f32 v224, v224, v115
    v_mfma_f32_32x32x16_bf16 v[120:135], v[80:83], v[152:155], v[120:135]
    v_add_f32 v224, v224, v116
    v_add_f32 v224, v224, v117
    v_add_f32 v224, v224, v118
    v_add_f32 v224, v224, v119
    v_mfma_f32_32x32x16_bf16 v[120:135], v[84:87], v[156:159], v[120:135]
    s_nop 9
    s_nop 1
    v_add_f32 v224, v224, v120
    v_add_f32 v224, v224, v121
    v_add_f32 v224, v224, v122
    v_add_f32 v224, v224, v123
    v_add_f32 v224, v224, v124
    v_add_f32 v224, v224, v125
    v_add_f32 v224, v224, v126
    v_add_f32 v224, v224, v127
    v_add_f32 v224, v224, v128
    v_add_f32 v224, v224, v129
    v_add_f32 v224, v224, v130
    v_add_f32 v224, v224, v131
    v_add_f32 v224, v224, v132
    v_add_f32 v224, v224, v133
    v_add_f32 v224, v224, v134
    v_add_f32 v224, v224, v135
    v_mov_b32 v225, v224
    s_nop 1
    v_permlane32_swap_b32 v224, v225
    v_add_f32 v224, v224, v225
    s_setpc_b64 s[48:49]
P_h4:
    ds_read_b128 v[184:187], v5 offset:0
    ds_read_b128 v[192:195], v5 offset:64
    ds_read_b128 v[200:203], v5 offset:128
    ds_read_b128 v[188:191], v6 offset:0
    ds_read_b128 v[196:199], v6 offset:64
    ds_read_b128 v[204:207], v6 offset:128
    s_mov_b32 m0, s55
    s_add_u32 s53, s56, 192
    buffer_load_dwordx4 v9, s[28:31], s56 offen offset:0 nt lds
    buffer_load_dwordx4 v10, s[28:31], s56 offen offset:1024 nt lds
    buffer_load_dwordx4 v11, s[28:31], s56 offen offset:2048 nt lds
    s_add_u32 m0, s55, 24576
    s_nop 0
    buffer_load_dwordx4 v9, s[28:31], s53 offen offset:0 nt lds
    buffer_load_dwordx4 v10, s[28:31], s53 offen offset:1024 nt lds
    buffer_load_dwordx4 v11, s[28:31], s53 offen offset:2048 nt lds
    s_waitcnt lgkmcnt(5)
    v_mfma_f32_32x32x16_bf16 v[136:151], v[208:211], v[184:187], v[88:103]
    s_mov_b32 m0, s58
    s_add_u32 s53, s59, 192
    buffer_load_dwordx4 v9, s[28:31], s59 offen offset:0 nt lds
    buffer_load_dwordx4 v10, s[28:31], s59 offen offset:1024 nt lds
    buffer_load_dwordx4 v11, s[28:31], s59 offen offset:2048 nt lds
    s_waitcnt lgkmcnt(4)
    v_mfma_f32_32x32x16_bf16 v[152:167], v[208:211], v[192:195], v[104:119]
    s_add_u32 m0, s58, 24576
    s_nop 0
    buffer_load_dwordx4 v9, s[28:31], s53 offen offset:0 nt lds
    buffer_load_dwordx4 v10, s[28:31], s53 offen offset:1024 nt lds
    buffer_load_dwordx4 v11, s[28:31], s53 offen offset:2048 nt lds
    s_waitcnt lgkmcnt(3)
    v_mfma_f32_32x32x16_bf16 v[168:183], v[208:211], v[200:203], v[120:135]
    s_branch P_s1
P_h0w:
    s_waitcnt vmcnt(0)
P_h0:
    ds_read_b128 v[184:187], v5 offset:0
    ds_read_b128 v[192:195], v5 offset:64
    ds_read_b128 v[200:203], v5 offset:128
    ds_read_b128 v[188:191], v6 offset:0
    ds_read_b128 v[196:199], v6 offset:64
    ds_read_b128 v[204:207], v6 offset:128
    s_waitcnt lgkmcnt(5)
    v_mfma_f32_32x32x16_bf16 v[136:151], v[208:211], v[184:187], v[88:103]
    s_waitcnt lgkmcnt(4)
    v_mfma_f32_32x32x16_bf16 v[152:167], v[208:211], v[192:195], v[104:119]
    s_waitcnt lgkmcnt(3)
    v_mfma_f32_32x32x16_bf16 v[168:183], v[208:211], v[200:203], v[120:135]
P_s1:
    s_waitcnt lgkmcnt(0)
    v_mfma_f32_32x32x16_bf16 v[136:151], v[212:215], v[188:191], v[136:151]
    v_mfma_f32_32x32x16_bf16 v[152:167], v[212:215], v[196:199], v[152:167]
    v_mfma_f32_16x16x32_bf16 v[220:223], v[216:219], v[184:187], v[224:227]
    v_mul_f32 v228, v136, v136
    v_fmac_f32 v228, v137, v137
    v_mfma_f32_32x32x16_bf16 v[168:183], v[212:215], v[204:207], v[168:183]
    v_fmac_f32 v228, v138, v138
    v_fmac_f32 v228, v139, v139
    v_fmac_f32 v228, v140, v140
    v_fmac_f32 v228, v141, v141
    v_fmac_f32 v228, v142, v142
    v_fmac_f32 v228, v143, v143
    v_mfma_f32_16x16x32_bf16 v[220:223], v[216:219], v[188:191], v[220:223]
    v_fmac_f32 v228, v144, v144
    v_fmac_f32 v228, v145, v145
    v_mfma_f32_16x16x32_bf16 v[220:223], v[216:219], v[192:195], v[220:223]
    v_fmac_f32 v228, v146, v146
    v_fmac_f32 v228, v147, v147
    v_mfma_f32_16x16x32_bf16 v[220:223], v[216:219], v[196:199], v[220:223]
    v_fmac_f32 v228, v148, v148
    v_fmac_f32 v228, v149, v149
    v_mfma_f32_16x16x32_bf16 v[220:223], v[216:219], v[200:203], v[220:223]
    v_fmac_f32 v228, v150, v150
    v_fmac_f32 v228, v151, v151
    v_mfma_f32_16x16x32_bf16 v[220:223], v[216:219], v[204:207], v[220:223]
    v_fmac_f32 v228, v152, v152
    v_fmac_f32 v228, v153, v153
    v_fmac_f32 v228, v154, v154
    v_fmac_f32 v228, v155, v155
    v_fmac_f32 v228, v156, v156
    v_fmac_f32 v228, v157, v157
    v_fmac_f32 v228, v158, v158
    v_fmac_f32 v228, v159, v159
    v_fmac_f32 v228, v160, v160
    v_fmac_f32 v228, v161, v161
    v_fmac_f32 v228, v162, v162
    v_fmac_f32 v228, v163, v163
    v_fmac_f32 v228, v164, v164
    v_fmac_f32 v228, v165, v165
    v_fmac_f32 v228, v166, v166
    v_fmac_f32 v228, v167, v167
    v_fmac_f32 v228, v168, v168
    v_fmac_f32 v228, v169, v169
    v_fmac_f32 v228, v170, v170
    v_fmac_f32 v228, v171, v171
    v_fmac_f32 v228, v172, v172
    v_fmac_f32 v228, v173, v173
    v_fmac_f32 v228, v174, v174
    v_fmac_f32 v228, v175, v175
    v_fmac_f32 v228, v176, v176
    v_fmac_f32 v228, v177, v177
    v_fmac_f32 v228, v178, v178
    v_fmac_f32 v228, v179, v179
    v_fmac_f32 v228, v180, v180
    v_fmac_f32 v228, v181, v181
    v_fmac_f32 v228, v182, v182
    v_fmac_f32 v228, v183, v183
    v_mov_b32 v229, v228
    v_fma_f32 v221, v220, v220, -s61
    s_nop 0
    v_permlane32_swap_b32 v228, v229
    v_add_f32 v228, v228, v229
    v_fma_f32 v228, v228, s62, -v221
    v_max_f32 v228, s61, v228
    v_rsq_f32 v228, v228
    v_add_u32 v15, 1, v15
    v_mul_f32 v229, -v220, v228
    v_mul_f32 v228, s62, v228
    v_fma_f32 v136, v136, v228, v229
    v_fma_f32 v137, v137, v228, v229
    v_fma_f32 v138, v138, v228, v229
    v_fma_f32 v139, v139, v228, v229
    v_fma_f32 v140, v140, v228, v229
    v_fma_f32 v141, v141, v228, v229
    v_fma_f32 v142, v142, v228, v229
    v_fma_f32 v143, v143, v228, v229
    v_cvt_pk_bf16_f32 v184, v136, v137
    v_cvt_pk_bf16_f32 v185, v138, v139
    v_cvt_pk_bf16_f32 v186, v140, v141
    v_cvt_pk_bf16_f32 v187, v142, v143
    ds_write_b128 v5, v[184:187] offset:0
    v_fma_f32 v144, v144, v228, v229
    v_fma_f32 v145, v145, v228, v229
    v_fma_f32 v146, v146, v228, v229
    v_fma_f32 v147, v147, v228, v229
    v_fma_f32 v148, v148, v228, v229
    v_fma_f32 v149, v149, v228, v229
    v_fma_f32 v150, v150, v228, v229
    v_fma_f32 v151, v151, v228, v229
    v_cvt_pk_bf16_f32 v188, v144, v145
    v_cvt_pk_bf16_f32 v189, v146, v147
    v_cvt_pk_bf16_f32 v190, v148, v149
    v_cvt_pk_bf16_f32 v191, v150, v151
    ds_write_b128 v6, v[188:191] offset:0
    v_fma_f32 v152, v152, v228, v229
    v_fma_f32 v153, v153, v228, v229
    v_fma_f32 v154, v154, v228, v229
    v_fma_f32 v155, v155, v228, v229
    v_fma_f32 v156, v156, v228, v229
    v_fma_f32 v157, v157, v228, v229
    v_fma_f32 v158, v158, v228, v229
    v_fma_f32 v159, v159, v228, v229
    v_cvt_pk_bf16_f32 v192, v152, v153
    v_cvt_pk_bf16_f32 v193, v154, v155
    v_cvt_pk_bf16_f32 v194, v156, v157
    v_cvt_pk_bf16_f32 v195, v158, v159
    ds_write_b128 v5, v[192:195] offset:64
    v_fma_f32 v160, v160, v228, v229
    v_fma_f32 v161, v161, v228, v229
    v_fma_f32 v162, v162, v228, v229
    v_fma_f32 v163, v163, v228, v229
    v_fma_f32 v164, v164, v228, v229
    v_fma_f32 v165, v165, v228, v229
    v_fma_f32 v166, v166, v228, v229
    v_fma_f32 v167, v167, v228, v229
    v_cvt_pk_bf16_f32 v196, v160, v161
    v_cvt_pk_bf16_f32 v197, v162, v163
    v_cvt_pk_bf16_f32 v198, v164, v165
    v_cvt_pk_bf16_f32 v199, v166, v167
    ds_write_b128 v6, v[196:199] offset:64
    v_fma_f32 v168, v168, v228, v229
    v_fma_f32 v169, v169, v228, v229
    v_fma_f32 v170, v170, v228, v229
    v_fma_f32 v171, v171, v228, v229
    v_fma_f32 v172, v172, v228, v229
    v_fma_f32 v173, v173, v228, v229
    v_fma_f32 v174, v174, v228, v229
    v_fma_f32 v175, v175, v228, v229
    v_cvt_pk_bf16_f32 v200, v168, v169
    v_cvt_pk_bf16_f32 v201, v170, v171
    v_cvt_pk_bf16_f32 v202, v172, v173
    v_cvt_pk_bf16_f32 v203, v174, v175
    ds_write_b128 v5, v[200:203] offset:128
    v_fma_f32 v176, v176, v228, v229
    v_fma_f32 v177, v177, v228, v229
    v_fma_f32 v178, v178, v228, v229
    v_fma_f32 v179, v179, v228, v229
    v_fma_f32 v180, v180, v228, v229
    v_fma_f32 v181, v181, v228, v229
    v_fma_f32 v182, v182, v228, v229
    v_fma_f32 v183, v183, v228, v229
    v_cvt_pk_bf16_f32 v204, v176, v177
    v_cvt_pk_bf16_f32 v205, v178, v179
    v_cvt_pk_bf16_f32 v206, v180, v181
    v_cvt_pk_bf16_f32 v207, v182, v183
    ds_write_b128 v6, v[204:207] offset:128
    v_add_u32 v5, 24576, v5
    v_add_u32 v6, 24576, v6
    s_waitcnt lgkmcnt(0)
    ds_write_b32 v14, v15
    s_setpc_b64 s[48:49]
L_cons:
    s_memrealtime s[58:59]
    s_getpc_b64 s[44:45]
L_pc:
    s_add_u32 s44, s44, standalone__detection_seg_mask2former__vision_kernel-L_pc
    s_addc_u32 s45, s45, -1
    v_add_u32 v0, -256, v0
    v_lshlrev_b32 v0, 7, v0
    v_min_u32 v0, L_codeend-standalone__detection_seg_mask2former__vision_kernel-4, v0
    global_load_dword v201, v0, s[44:45]
    s_sub_u32 s40, s3, 4
    v_lshlrev_b32 v2, 4, v1
    s_mul_i32 s48, s40, 4608
    v_add_u32 v12, s48, v2
    s_min_u32 s41, s40, 2
    s_lshl_b32 s46, s40, 2
    s_add_u32 s46, s46, s41
    s_lshl_b32 s46, s46, 10
    v_add_u32 v13, s46, v2
    s_lshl_b32 s54, s41, 10
    v_add_u32 v10, s54, v2
    s_lshr_b32 s50, s2, 3
    s_and_b32 s50, s50, 31
    s_mul_i32 s50, s50, 640
    v_lshlrev_b32 v14, 7, v1
    v_add_u32 v14, s50, v14
    v_min_u32 v14, 18428, v14
    v_and_b32 v244, 15, v1
    v_lshrrev_b32 v245, 4, v1
    v_bfe_u32 v246, v1, 2, 2
    v_and_b32 v247, 3, v1
    v_mul_u32_u24 v248, 192, v244
    v_lshl_add_u32 v248, v245, 4, v248
    v_lshl_add_u32 v249, v246, 3, v247
    v_mul_u32_u24 v249, 48, v249
    v_lshl_add_u32 v249, v245, 4, v249
    v_add_u32 v249, s48, v249
    s_waitcnt lgkmcnt(0)
    s_cmp_eq_u32 s40, 0
    s_cselect_b64 s[50:51], s[16:17], s[12:13]
    s_cmp_eq_u32 s40, 2
    s_cselect_b64 s[50:51], s[14:15], s[50:51]
    s_cmp_eq_u32 s40, 3
    s_cselect_b64 s[50:51], s[20:21], s[50:51]
    s_mov_b64 exec, 31
    global_load_dword v200, v14, s[50:51]
    s_mov_b64 exec, -1
    s_barrier
    s_lshl_b32 s50, s2, 2
    s_xor_b32 s50, s50, s40
    s_cmp_eq_u32 s50, 3
    s_cbranch_scc1 C_mknonce
C_mknonce_d:
    s_cmp_ge_u32 s40, 3
    s_cbranch_scc1 C_noy
    s_add_u32 m0, s54, 92160
    s_cmp_ge_u32 s40, 2
    global_load_lds_dwordx4 v10, s[4:5]
    s_cbranch_scc1 C_noy
    s_add_u32 s50, s20, 4096
    s_addc_u32 s51, s21, 0
    s_add_u32 m0, s46, 77824
    s_nop 0
    global_load_lds_dwordx4 v13, s[50:51]
C_noy:
    s_add_u32 m0, s46, 73728
    s_nop 0
    global_load_lds_dwordx4 v13, s[20:21] offset:0
    global_load_lds_dwordx4 v13, s[20:21] offset:1024
    global_load_lds_dwordx4 v13, s[20:21] offset:2048
    global_load_lds_dwordx4 v13, s[20:21] offset:3072
    v_mov_b32 v14, 163380
    v_mov_b32 v15, 1
    s_mov_b64 exec, 1
    ds_add_u32 v14, v15
    s_mov_b64 exec, -1
    s_mov_b32 s57, s46
    v_mov_b32 v12, v13
    v_mov_b32 v108, 0
    v_mov_b32 v109, 0
    v_mov_b32 v110, 0
    v_mov_b32 v111, 0
    v_mov_b32 v112, 0
    v_mov_b32 v113, 0
    v_mov_b32 v114, 0
    v_mov_b32 v115, 0
    v_mov_b32 v116, 0
    v_mov_b32 v117, 0
    v_mov_b32 v118, 0
    v_mov_b32 v119, 0
    v_mov_b32 v120, 0
    v_mov_b32 v121, 0
    v_mov_b32 v122, 0
    v_mov_b32 v123, 0
    v_mov_b32 v124, 0
    v_mov_b32 v125, 0
    v_mov_b32 v126, 0
    v_mov_b32 v127, 0
    v_mov_b32 v128, 0
    v_mov_b32 v129, 0
    v_mov_b32 v130, 0
    v_mov_b32 v131, 0
    s_mov_b32 s36, s26
    s_mov_b32 s37, s27
    s_mov_b32 s38, 1310720
    s_mov_b32 s39, 0x20000
    s_and_b32 s49, s40, 1
    s_lshl_b32 s55, s49, 1
    s_lshr_b32 s56, s40, 1
    s_add_u32 s55, s55, s56
    s_lshl_b32 s41, s2, 2
    s_add_u32 s41, s41, s55
    s_lshl_b32 s41, s41, 6
    v_mul_u32_u24 v3, 65536, v244
    v_lshl_add_u32 v3, v245, 4, v3
    v_add_u32 v3, s41, v3
    s_mul_i32 s52, s56, 12288
    v_and_b32 v250, 31, v1
    v_lshrrev_b32 v251, 5, v1
    v_lshlrev_b32 v252, 1, v244
    v_bfe_u32 v252, s63, v252, 2
    v_xor_b32 v252, v252, v251
    v_mul_u32_u24 v253, 192, v250
    v_add_u32 v253, s52, v253
    v_lshl_add_u32 v4, v252, 4, v253
    v_xor_b32 v252, 2, v252
    v_lshl_add_u32 v5, v252, 4, v253
    v_lshl_add_u32 v252, v251, 2, v246
    v_bfe_u32 v253, v1, 4, 1
    v_lshrrev_b32 v254, 1, v247
    v_lshl_add_u32 v254, v253, 1, v254
    v_and_b32 v255, 1, v247
    v_lshlrev_b32 v255, 3, v255
    v_add_u32 v255, s52, v255
    v_lshlrev_b32 v6, 1, v252
    v_bfe_u32 v6, s63, v6, 2
    v_xor_b32 v6, v6, v254
    v_lshl_add_u32 v6, v6, 4, v255
    v_mul_u32_u24 v10, 192, v252
    v_add_u32 v6, v6, v10
    v_add_u32 v252, 8, v252
    v_lshlrev_b32 v7, 1, v252
    v_bfe_u32 v7, s63, v7, 2
    v_xor_b32 v7, v7, v254
    v_lshl_add_u32 v7, v7, 4, v255
    v_mul_u32_u24 v10, 192, v252
    v_add_u32 v7, v7, v10
    v_lshl_add_u32 v8, v251, 2, v246
    v_lshl_add_u32 v8, v253, 4, v8
    v_mul_u32_u24 v8, 48, v8
    v_lshl_add_u32 v8, v247, 3, v8
    v_add_u32 v8, 144384, v8
    s_xor_b32 s41, s55, 1
    s_mul_i32 s53, s41, 4608
    s_mul_i32 s46, s55, 4608
    v_mov_b32 v10, s46
    v_mov_b32 v11, s53
    v_cmp_eq_u32 vcc, 0, v253
    v_mul_u32_u24 v9, 192, v244
    v_lshl_add_u32 v9, v251, 4, v9
    v_cndmask_b32 v10, v11, v10, vcc
    v_add_u32 v9, v9, v10
    v_add_u32 v9, 98304, v9
    v_lshl_add_u32 v252, v245, 3, v246
    v_mul_u32_u24 v10, 48, v252
    v_min_u32 v11, 2, v247
    v_lshl_add_u32 v10, v11, 4, v10
    s_add_u32 s41, s48, 98304
    v_add_u32 v10, s41, v10
    v_add_u32 v13, s41, v248
    v_add_u32 v248, 92160, v248
    v_mul_u32_u24 v11, 192, v252
    v_lshl_add_u32 v11, v247, 4, v11
    v_add_u32 v11, 73728, v11
    v_and_b32 v252, 1, v1
    v_cmp_eq_u32 vcc, v252, v253
    v_mov_b32 v252, 0x3f803f80
    v_mov_b32 v40, 0
    v_mov_b32 v41, 0
    v_cndmask_b32 v92, 0, v252, vcc
    v_cndmask_b32 v93, 0, v252, vcc
    v_cndmask_b32 v94, 0, v252, vcc
    v_cndmask_b32 v95, 0, v252, vcc
    v_mov_b32 v42, 0
    v_mov_b32 v43, 0
    v_mov_b32 v44, 0
    v_mov_b32 v45, 0
    v_mov_b32 v46, 0
    v_mov_b32 v47, 0
    v_mov_b32 v48, 0
    v_mov_b32 v49, 0
    v_mov_b32 v50, 0
    v_mov_b32 v51, 0
    v_mov_b32 v52, 0
    v_mov_b32 v53, 0
    v_mov_b32 v54, 0
    v_mov_b32 v55, 0
    v_mov_b32 v56, 0
    v_mov_b32 v57, 0
    v_mov_b32 v58, 0
    v_mov_b32 v59, 0
    v_mov_b32 v60, 0
    v_mov_b32 v61, 0
    v_mov_b32 v62, 0
    v_mov_b32 v63, 0
    v_mov_b32 v64, 0
    v_mov_b32 v65, 0
    v_mov_b32 v66, 0
    v_mov_b32 v67, 0
    v_mov_b32 v68, 0
    v_mov_b32 v69, 0
    v_mov_b32 v70, 0
    v_mov_b32 v71, 0
    v_mov_b32 v72, 0
    v_mov_b32 v73, 0
    v_mov_b32 v74, 0
    v_mov_b32 v75, 0
    v_mov_b32 v76, 0
    v_mov_b32 v77, 0
    v_mov_b32 v78, 0
    v_mov_b32 v79, 0
    v_mov_b32 v80, 0
    v_mov_b32 v81, 0
    v_mov_b32 v82, 0
    v_mov_b32 v83, 0
    v_mov_b32 v84, 0
    v_mov_b32 v85, 0
    v_mov_b32 v86, 0
    v_mov_b32 v87, 0
    v_mov_b32 v88, 0
    v_mov_b32 v89, 0
    v_mov_b32 v90, 0
    v_mov_b32 v91, 0
    s_cmp_ge_u32 s40, 2
    s_cbranch_scc1 C_nox
    s_add_u32 s50, s12, 4096
    s_addc_u32 s51, s13, 0
    s_add_u32 m0, s57, 102400
    s_nop 0
    global_load_lds_dwordx4 v12, s[50:51]
C_nox:
    s_add_u32 m0, s57, 98304
    s_nop 0
    global_load_lds_dwordx4 v12, s[12:13] offset:0
    global_load_lds_dwordx4 v12, s[12:13] offset:1024
    global_load_lds_dwordx4 v12, s[12:13] offset:2048
    global_load_lds_dwordx4 v12, s[12:13] offset:3072
    v_mov_b32 v14, 163384
    v_mov_b32 v15, 1
    s_mov_b64 exec, 1
    ds_add_u32 v14, v15
    s_mov_b64 exec, -1
    s_mov_b32 exec_hi, 0xffff
    global_load_dwordx4 v[108:111], v249, s[14:15] offset:0
    global_load_dwordx4 v[112:115], v249, s[14:15] offset:192
    global_load_dwordx4 v[116:119], v249, s[14:15] offset:1536
    global_load_dwordx4 v[120:123], v249, s[14:15] offset:1728
    global_load_dwordx4 v[124:127], v249, s[14:15] offset:3072
    global_load_dwordx4 v[128:131], v249, s[14:15] offset:3264
    s_mov_b32 exec_hi, -1
    v_add_u32 v8, s46, v8
    s_mul_i32 s41, s40, 6912
    s_xor_b32 s42, s40, 2
    s_mul_i32 s42, s42, 6912
    s_add_u32 s41, s41, 116736
    s_add_u32 s42, s42, 119808
    v_add_u32 v241, s41, v2
    v_lshlrev_b32 v245, 2, v1
    v_add_u32 v244, s42, v245
    v_add_u32 v245, s41, v245
    s_mov_b32 s52, 0xffff0000
    s_mov_b32 s53, 0xffff0000
    v_add_u32 v242, s42, v2
    v_and_b32 v240, 3, v1
    s_xor_b32 s41, s56, 1
    v_cmp_eq_u32 vcc, s41, v240
    v_lshlrev_b32 v240, 2, v240
    v_add_u32 v240, 163328, v240
    v_cndmask_b32 v255, 5, 4, vcc
    s_lshl_b32 s41, s40, 2
    s_add_u32 s41, s41, 163392
    v_mov_b32 v243, s41
    v_xor_b32 v0, 8, v243
    v_mov_b32 v251, 1
    s_mov_b32 s44, 0
    s_mov_b32 s45, -1
    v_bfe_u32 v247, v1, 1, 1
    v_cmp_eq_u32 vcc, s56, v247
    s_add_u32 s61, s56, 3
    s_mov_b32 s59, -6144
    s_mov_b32 s43, 0
    v_cndmask_b32 v247, 0, 1, vcc
    v_xor_b32 v246, 1, v247
    s_mul_i32 s96, s56, -24576
    s_add_u32 s96, s96, 12288
    s_sub_u32 s58, 24576, s96
    v_add_u32 v4, s96, v4
    v_add_u32 v5, s96, v5
    v_add_u32 v6, s96, v6
    v_add_u32 v7, s96, v7
    s_waitcnt vmcnt(6)
    v_mov_b32 v14, 163364
    v_mov_b32 v15, 1
    s_mov_b64 exec, 1
    ds_add_rtn_u32 v15, v14, v15
    s_mov_b64 exec, -1
    s_waitcnt lgkmcnt(0)
    v_readfirstlane_b32 s50, v15
    s_nop 3
    s_cmp_ge_u32 s50, 3
    s_cbranch_scc1 C_sy1_ok
C_sy1_spin:
    ds_read_b32 v15, v14
    s_waitcnt lgkmcnt(0)
    v_readfirstlane_b32 s50, v15
    s_nop 3
    s_cmp_lt_u32 s50, 4
    s_cbranch_scc1 C_sy1_spin
C_sy1_ok:
    ds_read_b128 v[96:99], v248 offset:0
    ds_read_b64_tr_b16 v[16:17], v10 offset:0
    ds_read_b64_tr_b16 v[18:19], v10 offset:192
    ds_read_b64_tr_b16 v[28:29], v10 offset:8
    ds_read_b64_tr_b16 v[30:31], v10 offset:200
    ds_read_b128 v[100:103], v248 offset:64
    ds_read_b64_tr_b16 v[20:21], v10 offset:1536
    ds_read_b64_tr_b16 v[22:23], v10 offset:1728
    ds_read_b64_tr_b16 v[32:33], v10 offset:1544
    ds_read_b64_tr_b16 v[34:35], v10 offset:1736
    ds_read_b128 v[104:107], v248 offset:128
    ds_read_b64_tr_b16 v[24:25], v10 offset:3072
    ds_read_b64_tr_b16 v[26:27], v10 offset:3264
    ds_read_b64_tr_b16 v[36:37], v10 offset:3080
    ds_read_b64_tr_b16 v[38:39], v10 offset:3272
    s_waitcnt lgkmcnt(12)
    v_mfma_f32_16x16x32_bf16 v[156:159], v[16:19], v[96:99], 0
    ds_read_b64_tr_b16 v[168:169], v11 offset:0
    ds_read_b64_tr_b16 v[170:171], v11 offset:768
    s_waitcnt lgkmcnt(12)
    v_mfma_f32_16x16x32_bf16 v[160:163], v[28:31], v[96:99], 0
    ds_read_b64_tr_b16 v[172:173], v11 offset:8
    ds_read_b64_tr_b16 v[174:175], v11 offset:776
    s_waitcnt lgkmcnt(11)
    v_mfma_f32_16x16x32_bf16 v[156:159], v[20:23], v[100:103], v[156:159]
    ds_read_b64_tr_b16 v[176:177], v11 offset:64
    ds_read_b64_tr_b16 v[178:179], v11 offset:832
    s_waitcnt lgkmcnt(11)
    v_mfma_f32_16x16x32_bf16 v[160:163], v[32:35], v[100:103], v[160:163]
    ds_read_b64_tr_b16 v[180:181], v11 offset:72
    ds_read_b64_tr_b16 v[182:183], v11 offset:840
    s_waitcnt lgkmcnt(10)
    v_mfma_f32_16x16x32_bf16 v[156:159], v[24:27], v[104:107], v[156:159]
    ds_read_b64_tr_b16 v[184:185], v11 offset:128
    ds_read_b64_tr_b16 v[186:187], v11 offset:896
    s_waitcnt lgkmcnt(10)
    v_mfma_f32_16x16x32_bf16 v[160:163], v[36:39], v[104:107], v[160:163]
    ds_read_b64_tr_b16 v[188:189], v11 offset:136
    ds_read_b64_tr_b16 v[190:191], v11 offset:904
    s_waitcnt lgkmcnt(10)
    v_mfma_f32_16x16x32_bf16 v[132:135], v[168:171], v[96:99], 0
    ds_read_b64_tr_b16 v[192:193], v11 offset:6144
    ds_read_b64_tr_b16 v[194:195], v11 offset:6912
    s_waitcnt lgkmcnt(10)
    v_mfma_f32_16x16x32_bf16 v[136:139], v[172:175], v[96:99], 0
    ds_read_b64_tr_b16 v[196:197], v11 offset:6152
    ds_read_b64_tr_b16 v[198:199], v11 offset:6920
    s_waitcnt lgkmcnt(10)
    v_mfma_f32_16x16x32_bf16 v[140:143], v[176:179], v[96:99], 0
    ds_read_b64_tr_b16 v[200:201], v11 offset:6208
    ds_read_b64_tr_b16 v[202:203], v11 offset:6976
    s_waitcnt lgkmcnt(10)
    v_mfma_f32_16x16x32_bf16 v[144:147], v[180:183], v[96:99], 0
    ds_read_b64_tr_b16 v[204:205], v11 offset:6216
    ds_read_b64_tr_b16 v[206:207], v11 offset:6984
    v_add_f32 v156, v156, v156
    s_waitcnt lgkmcnt(10)
    v_mfma_f32_16x16x32_bf16 v[148:151], v[184:187], v[96:99], 0
    ds_read_b64_tr_b16 v[208:209], v11 offset:6272
    ds_read_b64_tr_b16 v[210:211], v11 offset:7040
    v_add_f32 v157, v157, v157
    s_waitcnt lgkmcnt(10)
    v_mfma_f32_16x16x32_bf16 v[152:155], v[188:191], v[96:99], 0
    ds_read_b64_tr_b16 v[212:213], v11 offset:6280
    ds_read_b64_tr_b16 v[214:215], v11 offset:7048
    v_add_f32 v158, v158, v158
    s_waitcnt lgkmcnt(10)
    v_mfma_f32_16x16x32_bf16 v[132:135], v[192:195], v[100:103], v[132:135]
    ds_read_b64_tr_b16 v[216:217], v11 offset:12288
    ds_read_b64_tr_b16 v[218:219], v11 offset:13056
    v_add_f32 v159, v159, v159
    s_waitcnt lgkmcnt(10)
    v_mfma_f32_16x16x32_bf16 v[136:139], v[196:199], v[100:103], v[136:139]
    ds_read_b64_tr_b16 v[220:221], v11 offset:12296
    ds_read_b64_tr_b16 v[222:223], v11 offset:13064
    v_add_f32 v160, v160, v160
    s_waitcnt lgkmcnt(10)
    v_mfma_f32_16x16x32_bf16 v[140:143], v[200:203], v[100:103], v[140:143]
    ds_read_b64_tr_b16 v[224:225], v11 offset:12352
    ds_read_b64_tr_b16 v[226:227], v11 offset:13120
    v_add_f32 v161, v161, v161
    s_waitcnt lgkmcnt(10)
    v_mfma_f32_16x16x32_bf16 v[144:147], v[204:207], v[100:103], v[144:147]
    ds_read_b64_tr_b16 v[228:229], v11 offset:12360
    ds_read_b64_tr_b16 v[230:231], v11 offset:13128
    v_add_f32 v162, v162, v162
    s_waitcnt lgkmcnt(10)
    v_mfma_f32_16x16x32_bf16 v[148:151], v[208:211], v[100:103], v[148:151]
    ds_read_b64_tr_b16 v[232:233], v11 offset:12416
    ds_read_b64_tr_b16 v[234:235], v11 offset:13184
    v_add_f32 v163, v163, v163
    s_waitcnt lgkmcnt(10)
    v_mfma_f32_16x16x32_bf16 v[152:155], v[212:215], v[100:103], v[152:155]
    ds_read_b64_tr_b16 v[236:237], v11 offset:12424
    ds_read_b64_tr_b16 v[238:239], v11 offset:13192
    v_cvt_pk_bf16_f32 v164, v156, v157
    s_waitcnt lgkmcnt(10)
    v_mfma_f32_16x16x32_bf16 v[132:135], v[216:219], v[104:107], v[132:135]
    v_cvt_pk_bf16_f32 v165, v158, v159
    s_waitcnt lgkmcnt(8)
    v_mfma_f32_16x16x32_bf16 v[136:139], v[220:223], v[104:107], v[136:139]
    v_cvt_pk_bf16_f32 v166, v160, v161
    s_waitcnt lgkmcnt(6)
    v_mfma_f32_16x16x32_bf16 v[140:143], v[224:227], v[104:107], v[140:143]
    v_cvt_pk_bf16_f32 v167, v162, v163
    s_waitcnt lgkmcnt(4)
    v_mfma_f32_16x16x32_bf16 v[144:147], v[228:231], v[104:107], v[144:147]
    s_waitcnt lgkmcnt(2)
    v_mfma_f32_16x16x32_bf16 v[148:151], v[232:235], v[104:107], v[148:151]
    s_waitcnt lgkmcnt(0)
    v_mfma_f32_16x16x32_bf16 v[152:155], v[236:239], v[104:107], v[152:155]
    s_waitcnt vmcnt(0)
    v_mfma_f32_16x16x32_bf16 v[132:135], v[108:111], v[164:167], v[132:135]
    v_mfma_f32_16x16x32_bf16 v[136:139], v[112:115], v[164:167], v[136:139]
    v_mfma_f32_16x16x32_bf16 v[140:143], v[116:119], v[164:167], v[140:143]
    v_mfma_f32_16x16x32_bf16 v[144:147], v[120:123], v[164:167], v[144:147]
    v_mfma_f32_16x16x32_bf16 v[148:151], v[124:127], v[164:167], v[148:151]
    v_mfma_f32_16x16x32_bf16 v[152:155], v[128:131], v[164:167], v[152:155]
    s_mov_b32 s41, 0x3e16c740
    v_mul_f32 v132, s41, v132
    v_mul_f32 v133, s41, v133
    v_mul_f32 v134, s41, v134
    v_mul_f32 v135, s41, v135
    v_mul_f32 v136, s41, v136
    v_mul_f32 v137, s41, v137
    v_mul_f32 v138, s41, v138
    v_mul_f32 v139, s41, v139
    v_cvt_pk_bf16_f32 v132, v132, v133
    v_cvt_pk_bf16_f32 v133, v134, v135
    v_cvt_pk_bf16_f32 v134, v136, v137
    v_cvt_pk_bf16_f32 v135, v138, v139
    ds_write_b128 v13, v[132:135] offset:0
    s_nop 0
    v_mfma_f32_16x16x32_bf16 v[156:159], v[132:135], v[132:135], 0
    v_mul_f32 v140, s41, v140
    v_mul_f32 v141, s41, v141
    v_mul_f32 v142, s41, v142
    v_mul_f32 v143, s41, v143
    v_mul_f32 v144, s41, v144
    v_mul_f32 v145, s41, v145
    v_mul_f32 v146, s41, v146
    v_mul_f32 v147, s41, v147
    v_cvt_pk_bf16_f32 v140, v140, v141
    v_cvt_pk_bf16_f32 v141, v142, v143
    v_cvt_pk_bf16_f32 v142, v144, v145
    v_cvt_pk_bf16_f32 v143, v146, v147
    ds_write_b128 v13, v[140:143] offset:64
    s_nop 0
    v_mfma_f32_16x16x32_bf16 v[156:159], v[140:143], v[140:143], v[156:159]
    v_mul_f32 v148, s41, v148
    v_mul_f32 v149, s41, v149
    v_mul_f32 v150, s41, v150
    v_mul_f32 v151, s41, v151
    v_mul_f32 v152, s41, v152
    v_mul_f32 v153, s41, v153
    v_mul_f32 v154, s41, v154
    v_mul_f32 v155, s41, v155
    v_cvt_pk_bf16_f32 v148, v148, v149
    v_cvt_pk_bf16_f32 v149, v150, v151
    v_cvt_pk_bf16_f32 v150, v152, v153
    v_cvt_pk_bf16_f32 v151, v154, v155
    ds_write_b128 v13, v[148:151] offset:128
    s_nop 0
    v_mfma_f32_16x16x32_bf16 v[156:159], v[148:151], v[148:151], v[156:159]
    s_mov_b32 s41, 0x42844c39
    v_mov_b32 v14, 163372
    s_nop 5
    v_max3_f32 v156, v156, v157, v158
    v_max_f32 v156, v156, v159
    v_cmp_nge_f32 vcc, s41, v156
    s_nop 3
    s_cmp_eq_u64 vcc, 0
    s_cselect_b32 s51, 1, 0x101
    v_mov_b32 v15, s51
    s_waitcnt lgkmcnt(0)
    s_mov_b64 exec, 1
    ds_add_rtn_u32 v15, v14, v15
    s_mov_b64 exec, -1
    s_waitcnt lgkmcnt(0)
    v_readfirstlane_b32 s50, v15
    s_nop 3
    s_add_u32 s50, s50, s51
    s_cmp_eq_u32 s50, 4
    s_cbranch_scc1 C_sy3_ok
C_sy3:
    ds_read_b32 v15, v14
    s_waitcnt lgkmcnt(0)
    v_readfirstlane_b32 s50, v15
    s_nop 3
    s_cmp_lt_u32 s50, 4
    s_cbranch_scc1 C_sy3
    s_cmp_eq_u32 s50, 4
    s_cbranch_scc0 Z_sy3
C_sy3_ok:
    ds_read_b128 v[16:19], v9 offset:0
    ds_read_b128 v[20:23], v9 offset:32
    ds_read_b128 v[24:27], v9 offset:64
    ds_read_b128 v[28:31], v9 offset:96
    ds_read_b128 v[32:35], v9 offset:128
    ds_read_b128 v[36:39], v9 offset:160
    ds_read_b32 v252, v240
    ds_read_b128 v[96:99], v4 offset:0
    ds_read_b128 v[100:103], v5 offset:0
    ds_read_b128 v[104:107], v4 offset:64
    ds_read_b128 v[108:111], v5 offset:64
    ds_read_b128 v[112:115], v4 offset:128
    ds_read_b128 v[116:119], v5 offset:128
    v_mov_b32 v14, 163376
    s_waitcnt lgkmcnt(7)
    s_mov_b64 exec, 1
    ds_add_u32 v14, v251
    s_mov_b64 exec, -1
    s_waitcnt lgkmcnt(6)
    v_cmp_lt_u32 vcc, v252, v246
    s_cbranch_vccnz C_w0
C_g0:
    v_mov_b32 v246, v247
    s_branch C_go
C_w0:
    ds_read_b32 v252, v240
    s_waitcnt lgkmcnt(0)
    v_cmp_lt_u32 vcc, v252, v246
    s_cbranch_vccnz C_w0
    ds_read_b128 v[96:99], v4 offset:0
    ds_read_b128 v[100:103], v5 offset:0
    ds_read_b128 v[104:107], v4 offset:64
    ds_read_b128 v[108:111], v5 offset:64
    ds_read_b128 v[112:115], v4 offset:128
    ds_read_b128 v[116:119], v5 offset:128
    s_branch C_g0
C_loop:
    s_waitcnt lgkmcnt(6)
    v_cmp_lt_u32 vcc, v252, v246
    s_cbranch_vccnz C_wait
C_go:
    s_waitcnt lgkmcnt(5)
    v_mfma_f32_32x32x16_bf16 v[144:159], v[96:99], v[16:19], 0
    ds_read_b128 v[160:163], v4 offset:6144
    ds_read_b128 v[164:167], v5 offset:6144
    s_add_u32 s43, s43, 1
    v_add_u32 v246, v246, v247
    s_cmp_eq_u32 s43, 4
    s_cselect_b32 s60, s59, 24576
    s_cmp_eq_u32 s43, 1
    s_cselect_b32 s60, s58, s60
    ds_write_b32 v243, v4 offset:16
    s_waitcnt lgkmcnt(3)
    v_mfma_f32_32x32x16_bf16 v[144:159], v[100:103], v[20:23], v[144:159]
    ds_read_b128 v[168:171], v4 offset:6208
    ds_read_b128 v[172:175], v5 offset:6208
    v_mfma_f32_32x32x16_bf16 v[144:159], v[104:107], v[24:27], v[144:159]
    ds_read_b128 v[176:179], v4 offset:6272
    ds_read_b128 v[180:183], v5 offset:6272
    v_mfma_f32_32x32x16_bf16 v[144:159], v[108:111], v[28:31], v[144:159]
    ds_read_b64_tr_b16 v[120:121], v6 offset:0
    ds_read_b64_tr_b16 v[122:123], v7 offset:0
    v_mfma_f32_32x32x16_bf16 v[144:159], v[112:115], v[32:35], v[144:159]
    ds_read_b64_tr_b16 v[124:125], v6 offset:64
    ds_read_b64_tr_b16 v[126:127], v7 offset:64
    v_mfma_f32_32x32x16_bf16 v[144:159], v[116:119], v[36:39], v[144:159]
    ds_read_b64_tr_b16 v[128:129], v6 offset:128
    ds_read_b64_tr_b16 v[130:131], v7 offset:128
    s_waitcnt lgkmcnt(9)
    v_mfma_f32_32x32x16_bf16 v[184:199], v[160:163], v[16:19], 0
    ds_read_b64_tr_b16 v[132:133], v6 offset:3072
    ds_read_b64_tr_b16 v[134:135], v7 offset:3072
    ds_read_b64_tr_b16 v[136:137], v6 offset:3136
    ds_read_b64_tr_b16 v[138:139], v7 offset:3136
    v_mfma_f32_32x32x16_bf16 v[184:199], v[164:167], v[20:23], v[184:199]
    v_exp_f32 v144, v144
    v_exp_f32 v145, v145
    v_exp_f32 v146, v146
    v_mfma_f32_32x32x16_bf16 v[184:199], v[168:171], v[24:27], v[184:199]
    v_exp_f32 v147, v147
    v_exp_f32 v148, v148
    v_exp_f32 v149, v149
    s_waitcnt lgkmcnt(4)
    v_mfma_f32_32x32x16_bf16 v[184:199], v[172:175], v[28:31], v[184:199]
    v_exp_f32 v150, v150
    v_exp_f32 v151, v151
    v_cvt_pk_bf16_f32 v144, v144, v145
    v_cvt_pk_bf16_f32 v145, v146, v147
    v_mfma_f32_32x32x16_bf16 v[184:199], v[176:179], v[32:35], v[184:199]
    v_cvt_pk_bf16_f32 v146, v148, v149
    v_cvt_pk_bf16_f32 v147, v150, v151
    v_exp_f32 v152, v152
    v_exp_f32 v153, v153
    v_mfma_f32_32x32x16_bf16 v[184:199], v[180:183], v[36:39], v[184:199]
    ds_read_b64_tr_b16 v[140:141], v6 offset:3200
    ds_read_b64_tr_b16 v[142:143], v7 offset:3200
    v_exp_f32 v154, v154
    v_exp_f32 v155, v155
    v_mfma_f32_32x32x16_bf16 v[40:55], v[120:123], v[144:147], v[40:55]
    v_exp_f32 v156, v156
    v_exp_f32 v157, v157
    v_exp_f32 v158, v158
    v_mfma_f32_32x32x16_bf16 v[56:71], v[124:127], v[144:147], v[56:71]
    v_exp_f32 v159, v159
    v_cvt_pk_bf16_f32 v148, v152, v153
    v_cvt_pk_bf16_f32 v149, v154, v155
    v_cvt_pk_bf16_f32 v150, v156, v157
    v_cvt_pk_bf16_f32 v151, v158, v159
    v_mfma_f32_32x32x16_bf16 v[72:87], v[128:131], v[144:147], v[72:87]
    ds_read_b64_tr_b16 v[96:97], v6 offset:6144
    ds_read_b64_tr_b16 v[98:99], v7 offset:6144
    v_exp_f32 v184, v184
    v_exp_f32 v185, v185
    v_mfma_f32_16x16x32_bf16 v[88:91], v[92:95], v[144:147], v[88:91]
    v_exp_f32 v186, v186
    s_waitcnt lgkmcnt(2)
    v_mfma_f32_32x32x16_bf16 v[40:55], v[132:135], v[148:151], v[40:55]
    ds_read_b64_tr_b16 v[100:101], v6 offset:6208
    ds_read_b64_tr_b16 v[102:103], v7 offset:6208
    v_exp_f32 v187, v187
    v_exp_f32 v188, v188
    v_mfma_f32_32x32x16_bf16 v[56:71], v[136:139], v[148:151], v[56:71]
    ds_read_b64_tr_b16 v[104:105], v6 offset:6272
    ds_read_b64_tr_b16 v[106:107], v7 offset:6272
    v_exp_f32 v189, v189
    v_exp_f32 v190, v190
    v_mfma_f32_32x32x16_bf16 v[72:87], v[140:143], v[148:151], v[72:87]
    v_exp_f32 v191, v191
    v_cvt_pk_bf16_f32 v184, v184, v185
    v_cvt_pk_bf16_f32 v185, v186, v187
    v_cvt_pk_bf16_f32 v186, v188, v189
    v_cvt_pk_bf16_f32 v187, v190, v191
    v_mfma_f32_16x16x32_bf16 v[88:91], v[92:95], v[148:151], v[88:91]
    ds_read_b64_tr_b16 v[108:109], v6 offset:9216
    ds_read_b64_tr_b16 v[110:111], v7 offset:9216
    s_waitcnt lgkmcnt(4)
    v_mfma_f32_32x32x16_bf16 v[40:55], v[96:99], v[184:187], v[40:55]
    ds_read_b64_tr_b16 v[112:113], v6 offset:9280
    ds_read_b64_tr_b16 v[114:115], v7 offset:9280
    v_exp_f32 v192, v192
    v_exp_f32 v193, v193
    v_mfma_f32_32x32x16_bf16 v[56:71], v[100:103], v[184:187], v[56:71]
    ds_read_b64_tr_b16 v[116:117], v6 offset:9344
    ds_read_b64_tr_b16 v[118:119], v7 offset:9344
    v_exp_f32 v194, v194
    v_exp_f32 v195, v195
    s_waitcnt lgkmcnt(6)
    v_mfma_f32_32x32x16_bf16 v[72:87], v[104:107], v[184:187], v[72:87]
    v_exp_f32 v196, v196
    v_exp_f32 v197, v197
    v_exp_f32 v198, v198
    v_mfma_f32_16x16x32_bf16 v[88:91], v[92:95], v[184:187], v[88:91]
    v_exp_f32 v199, v199
    v_cvt_pk_bf16_f32 v188, v192, v193
    v_cvt_pk_bf16_f32 v189, v194, v195
    v_cvt_pk_bf16_f32 v190, v196, v197
    v_cvt_pk_bf16_f32 v191, v198, v199
    s_waitcnt lgkmcnt(0)
    v_add_u32 v4, s60, v4
    v_add_u32 v5, s60, v5
    v_add_u32 v6, s60, v6
    v_add_u32 v7, s60, v7
    ds_read_b32 v252, v240
    ds_read_b128 v[96:99], v4 offset:0
    ds_read_b128 v[100:103], v5 offset:0
    ds_read_b128 v[104:107], v4 offset:64
    v_mfma_f32_16x16x32_bf16 v[88:91], v[92:95], v[188:191], v[88:91]
    v_mfma_f32_32x32x16_bf16 v[40:55], v[108:111], v[188:191], v[40:55]
    ds_read_b128 v[108:111], v5 offset:64
    v_mfma_f32_32x32x16_bf16 v[56:71], v[112:115], v[188:191], v[56:71]
    ds_read_b128 v[112:115], v4 offset:128
    v_mfma_f32_32x32x16_bf16 v[72:87], v[116:119], v[188:191], v[72:87]
    ds_read_b128 v[116:119], v5 offset:128
    s_cmp_eq_u32 s43, s61
    s_cbranch_scc1 C_done
    s_load_dword s47, s[24:25], 0
    s_branch C_loop
C_wait:
    ds_read_b32 v252, v240
    s_waitcnt lgkmcnt(0)
    v_cmp_lt_u32 vcc, v252, v246
    s_cbranch_vccnz C_wait
    ds_read_b128 v[96:99], v4 offset:0
    ds_read_b128 v[100:103], v5 offset:0
    ds_read_b128 v[104:107], v4 offset:64
    ds_read_b128 v[108:111], v5 offset:64
    ds_read_b128 v[112:115], v4 offset:128
    ds_read_b128 v[116:119], v5 offset:128
    s_branch C_go
C_done:
    s_cmp_eq_u32 s47, 0
    s_cbranch_scc1 C_getnonce
C_getnonce_d:
    v_mov_b32 v246, v255
    s_waitcnt lgkmcnt(6)
    v_cmp_lt_u32 vcc, v252, v246
    s_cbranch_vccnz C_w13
C_g13:
    s_setprio 3
    s_waitcnt lgkmcnt(5)
    v_mfma_f32_32x32x16_bf16 v[144:159], v[96:99], v[16:19], 0
    ds_read_b128 v[160:163], v4 offset:24576
    ds_read_b128 v[164:167], v5 offset:24576
    s_waitcnt lgkmcnt(6)
    v_mfma_f32_32x32x16_bf16 v[144:159], v[100:103], v[20:23], v[144:159]
    ds_read_b128 v[168:171], v4 offset:24640
    ds_read_b128 v[172:175], v5 offset:24640
    s_waitcnt lgkmcnt(4)
    v_mfma_f32_32x32x16_bf16 v[144:159], v[104:107], v[24:27], v[144:159]
    ds_read_b128 v[176:179], v4 offset:24704
    ds_read_b128 v[180:183], v5 offset:24704
    v_mfma_f32_32x32x16_bf16 v[144:159], v[108:111], v[28:31], v[144:159]
    ds_read_b64_tr_b16 v[120:121], v6 offset:0
    ds_read_b64_tr_b16 v[122:123], v7 offset:0
    s_bfe_u32 s50, s47, 0xe0001
    s_and_b32 s51, s47, 0x8000
    s_or_b32 s50, s50, s51
    s_lshr_b32 s46, s47, 15
    v_mfma_f32_32x32x16_bf16 v[144:159], v[112:115], v[32:35], v[144:159]
    ds_read_b64_tr_b16 v[124:125], v6 offset:64
    ds_read_b64_tr_b16 v[126:127], v7 offset:64
    s_and_b32 s46, s46, 0x8000
    s_bfe_u32 s51, s47, 0xe0010
    s_or_b32 s51, s51, s46
    s_mov_b32 s46, 0xffff0000
    v_mfma_f32_32x32x16_bf16 v[144:159], v[116:119], v[36:39], v[144:159]
    ds_read_b64_tr_b16 v[128:129], v6 offset:128
    ds_read_b64_tr_b16 v[130:131], v7 offset:128
    v_mov_b32 v249, s50
    v_mov_b32 v250, s51
    v_cndmask_b32 v249, v249, v250, s[52:53]
    s_waitcnt lgkmcnt(4)
    v_mfma_f32_32x32x16_bf16 v[184:199], v[160:163], v[16:19], 0
    ds_read_b64_tr_b16 v[132:133], v6 offset:3072
    ds_read_b64_tr_b16 v[134:135], v7 offset:3072
    ds_read_b64_tr_b16 v[136:137], v6 offset:3136
    ds_read_b64_tr_b16 v[138:139], v7 offset:3136
    v_mfma_f32_32x32x16_bf16 v[184:199], v[164:167], v[20:23], v[184:199]
    v_exp_f32 v144, v144
    v_exp_f32 v145, v145
    v_exp_f32 v146, v146
    v_mfma_f32_32x32x16_bf16 v[184:199], v[168:171], v[24:27], v[184:199]
    v_exp_f32 v147, v147
    v_exp_f32 v148, v148
    v_exp_f32 v149, v149
    v_mfma_f32_32x32x16_bf16 v[184:199], v[172:175], v[28:31], v[184:199]
    v_exp_f32 v150, v150
    v_exp_f32 v151, v151
    v_cvt_pk_bf16_f32 v144, v144, v145
    v_cvt_pk_bf16_f32 v145, v146, v147
    v_mfma_f32_32x32x16_bf16 v[184:199], v[176:179], v[32:35], v[184:199]
    v_cvt_pk_bf16_f32 v146, v148, v149
    v_cvt_pk_bf16_f32 v147, v150, v151
    v_exp_f32 v152, v152
    v_exp_f32 v153, v153
    v_mfma_f32_32x32x16_bf16 v[184:199], v[180:183], v[36:39], v[184:199]
    ds_read_b64_tr_b16 v[140:141], v6 offset:3200
    ds_read_b64_tr_b16 v[142:143], v7 offset:3200
    v_exp_f32 v154, v154
    v_exp_f32 v155, v155
    v_mfma_f32_32x32x16_bf16 v[40:55], v[120:123], v[144:147], v[40:55]
    ds_read_b64_tr_b16 v[200:201], v8 offset:0
    ds_read_b64_tr_b16 v[202:203], v8 offset:384
    v_exp_f32 v156, v156
    v_exp_f32 v157, v157
    v_exp_f32 v158, v158
    s_waitcnt lgkmcnt(4)
    v_mfma_f32_32x32x16_bf16 v[56:71], v[124:127], v[144:147], v[56:71]
    ds_read_b64_tr_b16 v[212:213], v8 offset:32
    ds_read_b64_tr_b16 v[214:215], v8 offset:416
    v_exp_f32 v159, v159
    v_cvt_pk_bf16_f32 v148, v152, v153
    v_cvt_pk_bf16_f32 v149, v154, v155
    v_cvt_pk_bf16_f32 v150, v156, v157
    v_cvt_pk_bf16_f32 v151, v158, v159
    v_mfma_f32_32x32x16_bf16 v[72:87], v[128:131], v[144:147], v[72:87]
    ds_read_b64_tr_b16 v[96:97], v6 offset:24576
    ds_read_b64_tr_b16 v[98:99], v7 offset:24576
    v_exp_f32 v184, v184
    v_exp_f32 v185, v185
    v_mfma_f32_16x16x32_bf16 v[88:91], v[92:95], v[144:147], v[88:91]
    ds_read_b64_tr_b16 v[204:205], v8 offset:1536
    ds_read_b64_tr_b16 v[206:207], v8 offset:1920
    v_exp_f32 v186, v186
    v_mfma_f32_32x32x16_bf16 v[40:55], v[132:135], v[148:151], v[40:55]
    ds_read_b64_tr_b16 v[100:101], v6 offset:24640
    ds_read_b64_tr_b16 v[102:103], v7 offset:24640
    v_exp_f32 v187, v187
    v_exp_f32 v188, v188
    v_mfma_f32_32x32x16_bf16 v[56:71], v[136:139], v[148:151], v[56:71]
    ds_read_b64_tr_b16 v[104:105], v6 offset:24704
    ds_read_b64_tr_b16 v[106:107], v7 offset:24704
    v_exp_f32 v189, v189
    v_exp_f32 v190, v190
    s_waitcnt lgkmcnt(6)
    v_mfma_f32_32x32x16_bf16 v[72:87], v[140:143], v[148:151], v[72:87]
    ds_read_b64_tr_b16 v[216:217], v8 offset:1568
    ds_read_b64_tr_b16 v[218:219], v8 offset:1952
    v_exp_f32 v191, v191
    v_cvt_pk_bf16_f32 v184, v184, v185
    v_cvt_pk_bf16_f32 v185, v186, v187
    v_cvt_pk_bf16_f32 v186, v188, v189
    v_cvt_pk_bf16_f32 v187, v190, v191
    v_mfma_f32_16x16x32_bf16 v[88:91], v[92:95], v[148:151], v[88:91]
    ds_read_b64_tr_b16 v[108:109], v6 offset:27648
    ds_read_b64_tr_b16 v[110:111], v7 offset:27648
    v_mfma_f32_32x32x16_bf16 v[40:55], v[96:99], v[184:187], v[40:55]
    ds_read_b64_tr_b16 v[112:113], v6 offset:27712
    ds_read_b64_tr_b16 v[114:115], v7 offset:27712
    v_exp_f32 v192, v192
    v_exp_f32 v193, v193
    s_waitcnt lgkmcnt(4)
    v_mfma_f32_32x32x16_bf16 v[56:71], v[100:103], v[184:187], v[56:71]
    ds_read_b64_tr_b16 v[116:117], v6 offset:27776
    ds_read_b64_tr_b16 v[118:119], v7 offset:27776
    v_exp_f32 v194, v194
    v_exp_f32 v195, v195
    v_mfma_f32_32x32x16_bf16 v[72:87], v[104:107], v[184:187], v[72:87]
    ds_read_b64_tr_b16 v[208:209], v8 offset:3072
    ds_read_b64_tr_b16 v[210:211], v8 offset:3456
    v_exp_f32 v196, v196
    v_exp_f32 v197, v197
    v_exp_f32 v198, v198
    v_mfma_f32_16x16x32_bf16 v[88:91], v[92:95], v[184:187], v[88:91]
    ds_read_b64_tr_b16 v[220:221], v8 offset:3104
    ds_read_b64_tr_b16 v[222:223], v8 offset:3488
    v_exp_f32 v199, v199
    v_cvt_pk_bf16_f32 v188, v192, v193
    v_cvt_pk_bf16_f32 v189, v194, v195
    v_cvt_pk_bf16_f32 v190, v196, v197
    v_cvt_pk_bf16_f32 v191, v198, v199
    s_nop 1
    v_mfma_f32_16x16x32_bf16 v[88:91], v[92:95], v[188:191], v[88:91]
    s_waitcnt lgkmcnt(3)
    v_mfma_f32_32x32x16_bf16 v[40:55], v[108:111], v[188:191], v[40:55]
    v_mfma_f32_32x32x16_bf16 v[56:71], v[112:115], v[188:191], v[56:71]
    v_mfma_f32_32x32x16_bf16 v[72:87], v[116:119], v[188:191], v[72:87]
    s_waitcnt lgkmcnt(0)
C_epi:
    v_cndmask_b32 v248, v88, v89, s[44:45]
    v_and_b32 v250, s46, v248
    v_sub_f32 v248, v248, v250
    v_cndmask_b32 v248, v250, v248, s[52:53]
    v_bfi_b32 v248, s46, v248, v249
    ds_write_b32 v244, v248 offset:3072
    v_cvt_pk_bf16_f32 v96, v40, v41
    v_cvt_pk_bf16_f32 v97, v42, v43
    v_cvt_pk_bf16_f32 v98, v44, v45
    v_cvt_pk_bf16_f32 v99, v46, v47
    v_cvt_pk_bf16_f32 v100, v48, v49
    v_cvt_pk_bf16_f32 v101, v50, v51
    v_cvt_pk_bf16_f32 v102, v52, v53
    v_cvt_pk_bf16_f32 v103, v54, v55
    v_cvt_pk_bf16_f32 v104, v56, v57
    v_cvt_pk_bf16_f32 v105, v58, v59
    v_permlane16_swap_b32 v96, v100
    v_permlane16_swap_b32 v97, v101
    v_permlane16_swap_b32 v98, v102
    v_permlane16_swap_b32 v99, v103
    v_cvt_pk_bf16_f32 v106, v60, v61
    v_cvt_pk_bf16_f32 v107, v62, v63
    ds_write_b128 v242, v[100:103] offset:0
    v_cvt_pk_bf16_f32 v108, v64, v65
    v_cvt_pk_bf16_f32 v109, v66, v67
    v_cvt_pk_bf16_f32 v110, v68, v69
    v_cvt_pk_bf16_f32 v111, v70, v71
    v_cvt_pk_bf16_f32 v112, v72, v73
    v_cvt_pk_bf16_f32 v113, v74, v75
    v_permlane16_swap_b32 v104, v108
    v_permlane16_swap_b32 v105, v109
    v_permlane16_swap_b32 v106, v110
    v_permlane16_swap_b32 v107, v111
    v_cvt_pk_bf16_f32 v114, v76, v77
    v_cvt_pk_bf16_f32 v115, v78, v79
    ds_write_b128 v242, v[108:111] offset:1024
    v_cvt_pk_bf16_f32 v116, v80, v81
    v_cvt_pk_bf16_f32 v117, v82, v83
    v_cvt_pk_bf16_f32 v118, v84, v85
    v_cvt_pk_bf16_f32 v119, v86, v87
    s_nop 0
    v_permlane16_swap_b32 v112, v116
    v_permlane16_swap_b32 v113, v117
    v_permlane16_swap_b32 v114, v118
    v_permlane16_swap_b32 v115, v119
    s_nop 0
    ds_write_b128 v242, v[116:119] offset:2048
    ds_write_b32 v0, v251
    v_mfma_f32_16x16x32_bf16 v[120:123], v[200:203], v[96:99], 0
    v_mfma_f32_16x16x32_bf16 v[124:127], v[212:215], v[96:99], 0
    ds_read_b32 v15, v243
    ds_read_b128 v[128:131], v241 offset:3072
    ds_read_b128 v[132:135], v241 offset:4096
    ds_read_b128 v[136:139], v241 offset:5120
    ds_read_b32 v140, v245 offset:6144
    v_mfma_f32_16x16x32_bf16 v[120:123], v[204:207], v[104:107], v[120:123]
    v_mfma_f32_16x16x32_bf16 v[124:127], v[216:219], v[104:107], v[124:127]
    v_mfma_f32_16x16x32_bf16 v[120:123], v[208:211], v[112:115], v[120:123]
    v_mfma_f32_16x16x32_bf16 v[124:127], v[220:223], v[112:115], v[124:127]
C_xw:
    s_waitcnt lgkmcnt(4)
    v_cmp_eq_u32 vcc, 0, v15
    s_cbranch_vccnz C_xr
    s_waitcnt lgkmcnt(3)
    v_mfma_f32_16x16x32_bf16 v[120:123], v[200:203], v[128:131], v[120:123]
    v_mfma_f32_16x16x32_bf16 v[124:127], v[212:215], v[128:131], v[124:127]
    s_waitcnt lgkmcnt(2)
    v_mfma_f32_16x16x32_bf16 v[120:123], v[204:207], v[132:135], v[120:123]
    v_mfma_f32_16x16x32_bf16 v[124:127], v[216:219], v[132:135], v[124:127]
    s_waitcnt lgkmcnt(1)
    v_mfma_f32_16x16x32_bf16 v[120:123], v[208:211], v[136:139], v[120:123]
    v_mfma_f32_16x16x32_bf16 v[124:127], v[220:223], v[136:139], v[124:127]
    s_waitcnt lgkmcnt(0)
    v_cndmask_b32 v248, v248, v140, s[44:45]
    s_nop 1
    v_cvt_pk_bf16_f32 v120, v120, v121
    v_cvt_pk_bf16_f32 v121, v122, v123
    v_mov_b32 v123, v248
    s_nop 0
    v_cvt_pk_bf16_f32 v122, v124, v125
    v_cvt_pk_bf16_f32 v124, v126, v127
    s_nop 1
    v_permlane32_swap_b32 v122, v124
    buffer_store_dwordx4 v[120:123], v3, s[36:39], 0 offen sc1
    s_cmp_ge_u32 s2, 16
    s_cbranch_scc1 L_exit
    v_mov_b32 v14, 163388
    v_mov_b32 v15, 1
    s_mov_b64 exec, 1
    ds_add_u32 v14, v15
    s_mov_b64 exec, -1
    s_setprio 0
    s_branch L_comb
C_xr:
    ds_read_b32 v15, v243
    ds_read_b128 v[128:131], v241 offset:3072
    ds_read_b128 v[132:135], v241 offset:4096
    ds_read_b128 v[136:139], v241 offset:5120
    ds_read_b32 v140, v245 offset:6144
    s_branch C_xw
C_w13:
    ds_read_b32 v252, v240
    ds_read_b128 v[96:99], v4 offset:0
    ds_read_b128 v[100:103], v5 offset:0
    ds_read_b128 v[104:107], v4 offset:64
    ds_read_b128 v[108:111], v5 offset:64
    ds_read_b128 v[112:115], v4 offset:128
    ds_read_b128 v[116:119], v5 offset:128
    s_waitcnt lgkmcnt(6)
    v_cmp_lt_u32 vcc, v252, v246
    s_cbranch_vccz C_g13
    s_branch C_w13
C_mknonce:
    s_or_b32 s50, s58, 1
    v_mov_b32 v20, s50
    v_mov_b32 v21, 0
    v_mov_b32 v22, 0
    s_mov_b64 exec, 1
    global_atomic_cmpswap v22, v[20:21], s[24:25] sc1
    s_mov_b64 exec, -1
    s_branch C_mknonce_d
C_getnonce:
    s_memrealtime s[50:51]
    s_waitcnt lgkmcnt(0)
    s_or_b32 s47, s50, 1
    v_mov_b32 v248, s47
    v_mov_b32 v249, 0
    v_mov_b32 v250, 0
    s_mov_b64 exec, 1
    global_atomic_cmpswap v248, v250, v[248:249], s[24:25] sc0 sc1
    s_mov_b64 exec, -1
    s_waitcnt vmcnt(0)
    v_readfirstlane_b32 s50, v248
    s_nop 3
    s_cmp_eq_u32 s50, 0
    s_cselect_b32 s47, s47, s50
    s_branch C_getnonce_d
L_comb:
    v_lshlrev_b32 v2, 4, v1
    s_mul_i32 s40, s2, 65536
    s_lshl_b32 s41, s3, 13
    s_add_u32 s40, s40, s41
    s_add_u32 s41, s40, 4096
    v_and_b32 v6, 15, v1
    s_lshl_b32 s43, s3, 4
    v_add_u32 v6, s43, v6
    v_min_u32 v6, 95, v6
    s_mul_i32 s44, s2, 96
    v_add_u32 v6, s44, v6
    v_lshlrev_b32 v6, 1, v6
    global_load_ushort v7, v6, s[4:5]
    buffer_load_dwordx4 v[128:131], v2, s[36:39], s40 offen offset:0 sc1
    buffer_load_dwordx4 v[132:135], v2, s[36:39], s40 offen offset:1024 sc1
    buffer_load_dwordx4 v[136:139], v2, s[36:39], s40 offen offset:2048 sc1
    buffer_load_dwordx4 v[140:143], v2, s[36:39], s40 offen offset:3072 sc1
    buffer_load_dwordx4 v[144:147], v2, s[36:39], s41 offen offset:0 sc1
    buffer_load_dwordx4 v[148:151], v2, s[36:39], s41 offen offset:1024 sc1
    buffer_load_dwordx4 v[152:155], v2, s[36:39], s41 offen offset:2048 sc1
    buffer_load_dwordx4 v[156:159], v2, s[36:39], s41 offen offset:3072 sc1
    v_lshrrev_b32 v16, 4, v1
    v_bfe_u32 v28, v1, 2, 2
    v_and_b32 v19, 3, v1
    v_lshl_add_u32 v29, v16, 3, v28
    v_mul_u32_u24 v29, 192, v29
    v_lshl_add_u32 v29, v19, 3, v29
    s_lshl_b32 s45, s3, 5
    v_add_u32 v14, s45, v29
    v_and_b32 v28, 15, v1
    v_mul_u32_u24 v15, 384, v16
    v_lshl_add_u32 v15, v28, 4, v15
    s_mul_i32 s45, s3, 1536
    s_add_u32 s45, s45, 20480
    v_add_u32 v15, s45, v15
    v_and_b32 v29, 7, v1
    v_lshlrev_b32 v8, 2, v29
    s_mov_b32 s45, 0x75316240
    v_bfe_u32 v8, s45, v8, 4
    v_add_u32 v8, 48, v8
    v_cmp_lt_u32 vcc, 7, v28
    v_lshlrev_b32 v17, 6, v16
    s_nop 0
    v_cndmask_b32 v8, v29, v8, vcc
    v_lshl_add_u32 v8, v8, 3, v17
    v_add_u32 v8, 20480, v8
    s_lshl_b32 s45, s3, 8
    s_add_u32 s45, s45, 32768
    v_lshlrev_b32 v9, 2, v28
    v_mad_u32_u24 v9, v16, 48, v9
    v_mov_b32 v29, 192
    v_cmp_lt_u32 vcc, 11, v28
    v_lshlrev_b32 v10, 4, v16
    v_add_u32 v10, s45, v10
    v_cndmask_b32 v9, v9, v29, vcc
    v_add_u32 v9, s45, v9
    s_bfe_u32 s50, s47, 0xe0001
    s_and_b32 s51, s47, 0x8000
    s_or_b32 s50, s50, s51
    s_lshr_b32 s46, s47, 15
    s_and_b32 s46, s46, 0x8000
    s_bfe_u32 s51, s47, 0xe0010
    s_or_b32 s51, s51, s46
    s_mov_b32 s48, 0xaaaaaaaa
    s_mov_b32 s49, 0xaaaaaaaa
    v_mov_b32 v12, s50
    v_mov_b32 v13, s51
    v_cndmask_b32 v12, v12, v13, s[48:49]
    v_and_b32 v29, 1, v1
    v_lshlrev_b32 v29, 4, v29
    v_mov_b32 v17, 0x3f80
    v_lshlrev_b32 v29, v29, v17
    v_lshrrev_b32 v28, 1, v28
    v_cmp_eq_u32 vcc, 0, v28
    s_nop 1
    v_cndmask_b32 v24, 0, v29, vcc
    v_cmp_eq_u32 vcc, 1, v28
    s_nop 1
    v_cndmask_b32 v25, 0, v29, vcc
    v_cmp_eq_u32 vcc, 2, v28
    s_nop 1
    v_cndmask_b32 v26, 0, v29, vcc
    v_cmp_eq_u32 vcc, 3, v28
    s_nop 1
    v_cndmask_b32 v27, 0, v29, vcc
    v_mov_b32 v20, 0
    v_mov_b32 v21, 0
    v_mov_b32 v22, 0
    v_mov_b32 v23, 0
    s_mov_b32 s42, 0xff
    s_mov_b32 s43, 7
    s_waitcnt vmcnt(7)
    v_cmp_ne_u16 vcc, v12, v131
    s_cbranch_vccnz K_f0
    v_mfma_f32_16x16x32_bf16 v[20:23], v[24:27], v[128:131], v[20:23]
    s_bitset0_b32 s42, 0
K_f0:
    s_lshl_b32 s44, -2, s43
    s_and_b32 s44, s44, s42
    s_cselect_b32 s44, s44, s42
    s_ff1_i32_b32 s43, s44
    s_lshl_b32 s44, s43, 10
    s_add_u32 s44, s44, s40
    s_mov_b32 s6, s43
    buffer_load_dwordx4 v[128:131], v2, s[36:39], s44 offen sc1
    s_waitcnt vmcnt(7)
    v_cmp_ne_u16 vcc, v12, v135
    s_cbranch_vccnz K_f1
    v_mfma_f32_16x16x32_bf16 v[20:23], v[24:27], v[132:135], v[20:23]
    s_bitset0_b32 s42, 1
K_f1:
    s_lshl_b32 s44, -2, s43
    s_and_b32 s44, s44, s42
    s_cselect_b32 s44, s44, s42
    s_ff1_i32_b32 s43, s44
    s_lshl_b32 s44, s43, 10
    s_add_u32 s44, s44, s40
    s_mov_b32 s7, s43
    buffer_load_dwordx4 v[132:135], v2, s[36:39], s44 offen sc1
    s_waitcnt vmcnt(7)
    v_cmp_ne_u16 vcc, v12, v139
    s_cbranch_vccnz K_f2
    v_mfma_f32_16x16x32_bf16 v[20:23], v[24:27], v[136:139], v[20:23]
    s_bitset0_b32 s42, 2
K_f2:
    s_lshl_b32 s44, -2, s43
    s_and_b32 s44, s44, s42
    s_cselect_b32 s44, s44, s42
    s_ff1_i32_b32 s43, s44
    s_lshl_b32 s44, s43, 10
    s_add_u32 s44, s44, s40
    s_mov_b32 s8, s43
    buffer_load_dwordx4 v[136:139], v2, s[36:39], s44 offen sc1
    s_waitcnt vmcnt(7)
    v_cmp_ne_u16 vcc, v12, v143
    s_cbranch_vccnz K_f3
    v_mfma_f32_16x16x32_bf16 v[20:23], v[24:27], v[140:143], v[20:23]
    s_bitset0_b32 s42, 3
K_f3:
    s_lshl_b32 s44, -2, s43
    s_and_b32 s44, s44, s42
    s_cselect_b32 s44, s44, s42
    s_ff1_i32_b32 s43, s44
    s_lshl_b32 s44, s43, 10
    s_add_u32 s44, s44, s40
    s_mov_b32 s9, s43
    buffer_load_dwordx4 v[140:143], v2, s[36:39], s44 offen sc1
    s_waitcnt vmcnt(7)
    v_cmp_ne_u16 vcc, v12, v147
    s_cbranch_vccnz K_f4
    v_mfma_f32_16x16x32_bf16 v[20:23], v[24:27], v[144:147], v[20:23]
    s_bitset0_b32 s42, 4
K_f4:
    s_lshl_b32 s44, -2, s43
    s_and_b32 s44, s44, s42
    s_cselect_b32 s44, s44, s42
    s_ff1_i32_b32 s43, s44
    s_lshl_b32 s44, s43, 10
    s_add_u32 s44, s44, s40
    s_mov_b32 s10, s43
    buffer_load_dwordx4 v[144:147], v2, s[36:39], s44 offen sc1
    s_waitcnt vmcnt(7)
    v_cmp_ne_u16 vcc, v12, v151
    s_cbranch_vccnz K_f5
    v_mfma_f32_16x16x32_bf16 v[20:23], v[24:27], v[148:151], v[20:23]
    s_bitset0_b32 s42, 5
K_f5:
    s_waitcnt vmcnt(6)
    v_cmp_ne_u16 vcc, v12, v155
    s_cbranch_vccnz K_f6
    v_mfma_f32_16x16x32_bf16 v[20:23], v[24:27], v[152:155], v[20:23]
    s_bitset0_b32 s42, 6
K_f6:
    s_waitcnt vmcnt(5)
    v_cmp_ne_u16 vcc, v12, v159
    s_cbranch_vccnz K_f7
    v_mfma_f32_16x16x32_bf16 v[20:23], v[24:27], v[156:159], v[20:23]
    s_bitset0_b32 s42, 7
    s_cmp_eq_u32 s42, 0
    s_cbranch_scc1 K_red0
K_f7:
K_chk:
    s_waitcnt vmcnt(4)
    v_cmp_ne_u16 vcc, v12, v131
    s_cbranch_vccnz K_n0
    s_bitcmp0_b32 s42, s6
    s_cbranch_scc1 K_n0
    v_mfma_f32_16x16x32_bf16 v[20:23], v[24:27], v[128:131], v[20:23]
    s_bitset0_b32 s42, s6
    s_cmp_eq_u32 s42, 0
    s_cbranch_scc1 K_red0
K_n0:
    s_lshl_b32 s44, -2, s43
    s_and_b32 s44, s44, s42
    s_cselect_b32 s44, s44, s42
    s_ff1_i32_b32 s43, s44
    s_lshl_b32 s44, s43, 10
    s_add_u32 s44, s44, s40
    s_mov_b32 s6, s43
    buffer_load_dwordx4 v[128:131], v2, s[36:39], s44 offen sc1
    s_waitcnt vmcnt(4)
    v_cmp_ne_u16 vcc, v12, v135
    s_cbranch_vccnz K_n1
    s_bitcmp0_b32 s42, s7
    s_cbranch_scc1 K_n1
    v_mfma_f32_16x16x32_bf16 v[20:23], v[24:27], v[132:135], v[20:23]
    s_bitset0_b32 s42, s7
    s_cmp_eq_u32 s42, 0
    s_cbranch_scc1 K_red0
K_n1:
    s_lshl_b32 s44, -2, s43
    s_and_b32 s44, s44, s42
    s_cselect_b32 s44, s44, s42
    s_ff1_i32_b32 s43, s44
    s_lshl_b32 s44, s43, 10
    s_add_u32 s44, s44, s40
    s_mov_b32 s7, s43
    buffer_load_dwordx4 v[132:135], v2, s[36:39], s44 offen sc1
    s_waitcnt vmcnt(4)
    v_cmp_ne_u16 vcc, v12, v139
    s_cbranch_vccnz K_n2
    s_bitcmp0_b32 s42, s8
    s_cbranch_scc1 K_n2
    v_mfma_f32_16x16x32_bf16 v[20:23], v[24:27], v[136:139], v[20:23]
    s_bitset0_b32 s42, s8
    s_cmp_eq_u32 s42, 0
    s_cbranch_scc1 K_red0
K_n2:
    s_lshl_b32 s44, -2, s43
    s_and_b32 s44, s44, s42
    s_cselect_b32 s44, s44, s42
    s_ff1_i32_b32 s43, s44
    s_lshl_b32 s44, s43, 10
    s_add_u32 s44, s44, s40
    s_mov_b32 s8, s43
    buffer_load_dwordx4 v[136:139], v2, s[36:39], s44 offen sc1
    s_waitcnt vmcnt(4)
    v_cmp_ne_u16 vcc, v12, v143
    s_cbranch_vccnz K_n3
    s_bitcmp0_b32 s42, s9
    s_cbranch_scc1 K_n3
    v_mfma_f32_16x16x32_bf16 v[20:23], v[24:27], v[140:143], v[20:23]
    s_bitset0_b32 s42, s9
    s_cmp_eq_u32 s42, 0
    s_cbranch_scc1 K_red0
K_n3:
    s_lshl_b32 s44, -2, s43
    s_and_b32 s44, s44, s42
    s_cselect_b32 s44, s44, s42
    s_ff1_i32_b32 s43, s44
    s_lshl_b32 s44, s43, 10
    s_add_u32 s44, s44, s40
    s_mov_b32 s9, s43
    buffer_load_dwordx4 v[140:143], v2, s[36:39], s44 offen sc1
    s_waitcnt vmcnt(4)
    v_cmp_ne_u16 vcc, v12, v147
    s_cbranch_vccnz K_n4
    s_bitcmp0_b32 s42, s10
    s_cbranch_scc1 K_n4
    v_mfma_f32_16x16x32_bf16 v[20:23], v[24:27], v[144:147], v[20:23]
    s_bitset0_b32 s42, s10
    s_cmp_eq_u32 s42, 0
    s_cbranch_scc1 K_red0
K_n4:
    s_lshl_b32 s44, -2, s43
    s_and_b32 s44, s44, s42
    s_cselect_b32 s44, s44, s42
    s_ff1_i32_b32 s43, s44
    s_lshl_b32 s44, s43, 10
    s_add_u32 s44, s44, s40
    s_mov_b32 s10, s43
    buffer_load_dwordx4 v[144:147], v2, s[36:39], s44 offen sc1
    s_branch K_chk
K_red0:
K_red:
    s_cmp_ge_u32 s3, 6
    s_cbranch_scc1 K_67
    s_nop 2
    ds_write_b128 v15, v[20:23]
    s_waitcnt lgkmcnt(0)
    s_barrier
    ds_read2st64_b64 v[56:59], v8 offset0:0 offset1:3
    ds_read2st64_b64 v[60:63], v8 offset0:6 offset1:9
    ds_read2st64_b64 v[64:67], v8 offset0:12 offset1:15
    ds_read2st64_b64 v[68:71], v8 offset0:18 offset1:21
    ds_read_b64_tr_b16 v[40:41], v14 offset:0
    ds_read_b64_tr_b16 v[42:43], v14 offset:768
    ds_read_b64_tr_b16 v[44:45], v14 offset:6144
    ds_read_b64_tr_b16 v[46:47], v14 offset:6912
    ds_read_b64_tr_b16 v[48:49], v14 offset:12288
    ds_read_b64_tr_b16 v[50:51], v14 offset:13056
    v_lshlrev_b32 v7, 16, v7
    s_waitcnt lgkmcnt(8)
    v_add_f32 v56, v56, v60
    v_add_f32 v57, v57, v61
    v_add_f32 v58, v58, v62
    v_add_f32 v59, v59, v63
    s_waitcnt lgkmcnt(6)
    v_add_f32 v64, v64, v68
    v_add_f32 v65, v65, v69
    v_add_f32 v66, v66, v70
    v_add_f32 v67, v67, v71
    v_add_f32 v56, v56, v64
    v_add_f32 v58, v58, v66
    v_add_f32 v57, v57, v65
    v_add_f32 v59, v59, v67
    v_add_f32 v56, v56, v58
    v_add_f32 v57, v57, v59
    s_nop 1
    v_add_f32_dpp v58, v57, v57 quad_perm:[1,0,3,2] row_mask:0xf bank_mask:0xf
    s_nop 1
    v_add_f32_dpp v58, v58, v58 quad_perm:[2,3,0,1] row_mask:0xf bank_mask:0xf
    s_nop 1
    v_mov_b32_dpp v58, v58 row_newbcast:12 row_mask:0xf bank_mask:0xf
    v_rcp_f32 v58, v58
    s_nop 0
    v_mul_f32 v56, v56, v58
    v_mul_f32 v57, v57, v58
    v_cvt_pk_bf16_f32 v56, v56, v57
    ds_write_b32 v9, v56
    ds_read_b128 v[60:63], v10 offset:0
    ds_read_b128 v[64:67], v10 offset:64
    ds_read_b128 v[68:71], v10 offset:128
    s_waitcnt lgkmcnt(2)
    v_mfma_f32_16x16x32_bf16 v[88:91], v[60:63], v[40:43], 0
    s_waitcnt lgkmcnt(1)
    v_mfma_f32_16x16x32_bf16 v[88:91], v[64:67], v[44:47], v[88:91]
    s_waitcnt lgkmcnt(0)
    v_mfma_f32_16x16x32_bf16 v[88:91], v[68:71], v[48:51], v[88:91]
    s_nop 7
    v_cvt_pk_bf16_f32 v88, v88, v88
    v_and_b32 v88, 0xffff0000, v88
    v_add_f32 v88, v88, v7
    v_cvt_pk_bf16_f32 v88, v88, v88
    s_mov_b64 exec, 0xffff
    s_waitcnt vmcnt(0)
    global_store_short v6, v88, s[22:23]
    s_mov_b64 exec, -1
L_exit:
L_end:
    s_endpgm
K_67:
    s_nop 2
    ds_write_b128 v15, v[20:23]
    s_waitcnt lgkmcnt(0)
    s_barrier
    s_waitcnt vmcnt(0)
    s_branch L_exit
L_codeend:
Z_sy3:
    ds_read_b32 v15, v14
    s_waitcnt lgkmcnt(0)
    v_readfirstlane_b32 s50, v15
    s_nop 3
    s_and_b32 s50, s50, 0xff
    s_cmp_lt_u32 s50, 4
    s_cbranch_scc1 Z_sy3
    v_mov_b32 v160, 0xff61b1e6
    v_subrev_u32 v4, s96, v4
    v_subrev_u32 v5, s96, v5
    v_subrev_u32 v6, s96, v6
    v_subrev_u32 v7, s96, v7
    ds_read_b128 v[16:19], v9 offset:0
    ds_read_b128 v[20:23], v9 offset:32
    ds_read_b128 v[24:27], v9 offset:64
    ds_read_b128 v[28:31], v9 offset:96
    ds_read_b128 v[32:35], v9 offset:128
    ds_read_b128 v[36:39], v9 offset:160
    s_lshl_b32 s41, s56, 3
    s_add_u32 s41, s41, 163328
    v_mov_b32 v10, s41
    s_mov_b32 s43, 1
    s_waitcnt lgkmcnt(0)
    v_mov_b32 v14, 163376
    v_mov_b32 v15, 1
    s_mov_b64 exec, 1
    ds_add_u32 v14, v15
    s_mov_b64 exec, -1
    s_lshl_b32 s41, s55, 8
    s_add_u32 s41, s41, s2
    s_lshl_b32 s41, s41, 3
    s_add_u32 s41, s41, 1179648
    v_and_b32 v254, 15, v1
    v_lshlrev_b32 v254, 13, v254
    v_add_u32 v254, s41, v254
    s_call_b64 s[60:61], Z_blk
    s_load_dword s47, s[24:25], 0
    s_call_b64 s[60:61], Z_blk
    ds_write_b32 v243, v4 offset:16
    s_cmp_eq_u32 s47, 0
    s_cbranch_scc1 Z_getnonce
Z_getnonce_d:
    s_bfe_u32 s50, s47, 0xe0001
    s_and_b32 s51, s47, 0x8000
    s_or_b32 s50, s50, s51
    s_lshr_b32 s46, s47, 15
    s_and_b32 s46, s46, 0x8000
    s_bfe_u32 s51, s47, 0xe0010
    s_or_b32 s51, s51, s46
    s_mov_b32 s46, 0xffff0000
    v_mov_b32 v249, s50
    v_mov_b32 v250, s51
    v_cndmask_b32 v249, v249, v250, s[52:53]
    s_call_b64 s[60:61], Z_blk
    s_cmp_eq_u32 s56, 0
    s_cbranch_scc1 Z_r3s
    s_call_b64 s[60:61], Z_blk
    s_mov_b32 s51, -30720
    v_add_u32 v4, s51, v4
    v_add_u32 v5, s51, v5
    v_add_u32 v6, s51, v6
    v_add_u32 v7, s51, v7
Z_r4w1:
    ds_read_b32 v252, v240
    s_waitcnt lgkmcnt(0)
    v_cmp_lt_u32 vcc, v252, v255
    s_cbranch_vccnz Z_r4w1
    s_setprio 3
    ds_read_b128 v[96:99], v4 offset:0
    ds_read_b128 v[100:103], v5 offset:0
    ds_read_b128 v[104:107], v4 offset:64
    ds_read_b128 v[108:111], v5 offset:64
    ds_read_b128 v[112:115], v4 offset:128
    ds_read_b128 v[116:119], v5 offset:128
    s_waitcnt lgkmcnt(0)
    ds_read_b64_tr_b16 v[120:121], v6 offset:0
    ds_read_b64_tr_b16 v[122:123], v7 offset:0
    ds_read_b64_tr_b16 v[124:125], v6 offset:64
    ds_read_b64_tr_b16 v[126:127], v7 offset:64
    ds_read_b64_tr_b16 v[128:129], v6 offset:128
    ds_read_b64_tr_b16 v[130:131], v7 offset:128
    ds_read_b64_tr_b16 v[132:133], v6 offset:3072
    ds_read_b64_tr_b16 v[134:135], v7 offset:3072
    ds_read_b64_tr_b16 v[136:137], v6 offset:3136
    ds_read_b64_tr_b16 v[138:139], v7 offset:3136
    ds_read_b64_tr_b16 v[140:141], v6 offset:3200
    ds_read_b64_tr_b16 v[142:143], v7 offset:3200
    v_mfma_f32_32x32x16_bf16 v[144:159], v[96:99], v[16:19], 0
    v_mfma_f32_32x32x16_bf16 v[144:159], v[100:103], v[20:23], v[144:159]
    v_mfma_f32_32x32x16_bf16 v[144:159], v[104:107], v[24:27], v[144:159]
    v_mfma_f32_32x32x16_bf16 v[144:159], v[108:111], v[28:31], v[144:159]
    v_mfma_f32_32x32x16_bf16 v[144:159], v[112:115], v[32:35], v[144:159]
    v_mfma_f32_32x32x16_bf16 v[144:159], v[116:119], v[36:39], v[144:159]
    s_nop 15
    s_nop 15
    v_max3_f32 v161, v144, v145, v146
    v_max3_f32 v161, v161, v147, v148
    v_max3_f32 v161, v161, v149, v150
    v_max3_f32 v161, v161, v151, v152
    v_max3_f32 v161, v161, v153, v154
    v_max3_f32 v161, v161, v155, v156
    v_max3_f32 v161, v161, v157, v158
    v_max_f32 v161, v161, v159
    v_mov_b32 v162, v161
    s_nop 1
    v_permlane32_swap_b32 v161, v162
    s_nop 1
    v_max_f32 v161, v161, v162
    v_max_f32 v161, v161, v160
    v_sub_f32 v164, v160, v161
    v_exp_f32 v164, v164
    v_mov_b32 v160, v161
    s_nop 1
    v_mov_b32 v165, v164
    v_mov_b32 v166, v164
    s_nop 1
    v_permlane16_swap_b32 v165, v166
    s_nop 1
    v_mul_f32 v40, v40, v164
    v_mul_f32 v41, v41, v164
    v_mul_f32 v42, v42, v164
    v_mul_f32 v43, v43, v164
    v_mul_f32 v44, v44, v164
    v_mul_f32 v45, v45, v164
    v_mul_f32 v46, v46, v164
    v_mul_f32 v47, v47, v164
    v_mul_f32 v48, v48, v164
    v_mul_f32 v49, v49, v164
    v_mul_f32 v50, v50, v164
    v_mul_f32 v51, v51, v164
    v_mul_f32 v52, v52, v164
    v_mul_f32 v53, v53, v164
    v_mul_f32 v54, v54, v164
    v_mul_f32 v55, v55, v164
    v_mul_f32 v56, v56, v164
    v_mul_f32 v57, v57, v164
    v_mul_f32 v58, v58, v164
    v_mul_f32 v59, v59, v164
    v_mul_f32 v60, v60, v164
    v_mul_f32 v61, v61, v164
    v_mul_f32 v62, v62, v164
    v_mul_f32 v63, v63, v164
    v_mul_f32 v64, v64, v164
    v_mul_f32 v65, v65, v164
    v_mul_f32 v66, v66, v164
    v_mul_f32 v67, v67, v164
    v_mul_f32 v68, v68, v164
    v_mul_f32 v69, v69, v164
    v_mul_f32 v70, v70, v164
    v_mul_f32 v71, v71, v164
    v_mul_f32 v72, v72, v164
    v_mul_f32 v73, v73, v164
    v_mul_f32 v74, v74, v164
    v_mul_f32 v75, v75, v164
    v_mul_f32 v76, v76, v164
    v_mul_f32 v77, v77, v164
    v_mul_f32 v78, v78, v164
    v_mul_f32 v79, v79, v164
    v_mul_f32 v80, v80, v164
    v_mul_f32 v81, v81, v164
    v_mul_f32 v82, v82, v164
    v_mul_f32 v83, v83, v164
    v_mul_f32 v84, v84, v164
    v_mul_f32 v85, v85, v164
    v_mul_f32 v86, v86, v164
    v_mul_f32 v87, v87, v164
    v_mul_f32 v88, v88, v165
    v_mul_f32 v89, v89, v166
    v_mul_f32 v90, v90, v165
    v_mul_f32 v91, v91, v166
    v_sub_f32 v144, v144, v160
    v_sub_f32 v145, v145, v160
    v_sub_f32 v146, v146, v160
    v_sub_f32 v147, v147, v160
    v_sub_f32 v148, v148, v160
    v_sub_f32 v149, v149, v160
    v_sub_f32 v150, v150, v160
    v_sub_f32 v151, v151, v160
    v_sub_f32 v152, v152, v160
    v_sub_f32 v153, v153, v160
    v_sub_f32 v154, v154, v160
    v_sub_f32 v155, v155, v160
    v_sub_f32 v156, v156, v160
    v_sub_f32 v157, v157, v160
    v_sub_f32 v158, v158, v160
    v_sub_f32 v159, v159, v160
    v_exp_f32 v144, v144
    v_exp_f32 v145, v145
    v_exp_f32 v146, v146
    v_exp_f32 v147, v147
    v_exp_f32 v148, v148
    v_exp_f32 v149, v149
    v_exp_f32 v150, v150
    v_exp_f32 v151, v151
    v_exp_f32 v152, v152
    v_exp_f32 v153, v153
    v_exp_f32 v154, v154
    v_exp_f32 v155, v155
    v_exp_f32 v156, v156
    v_exp_f32 v157, v157
    v_exp_f32 v158, v158
    v_exp_f32 v159, v159
    s_nop 1
    v_cvt_pk_bf16_f32 v144, v144, v145
    v_cvt_pk_bf16_f32 v145, v146, v147
    v_cvt_pk_bf16_f32 v146, v148, v149
    v_cvt_pk_bf16_f32 v147, v150, v151
    v_cvt_pk_bf16_f32 v148, v152, v153
    v_cvt_pk_bf16_f32 v149, v154, v155
    v_cvt_pk_bf16_f32 v150, v156, v157
    v_cvt_pk_bf16_f32 v151, v158, v159
    s_waitcnt lgkmcnt(0)
    s_nop 1
    v_mfma_f32_32x32x16_bf16 v[40:55], v[120:123], v[144:147], v[40:55]
    v_mfma_f32_32x32x16_bf16 v[56:71], v[124:127], v[144:147], v[56:71]
    v_mfma_f32_32x32x16_bf16 v[72:87], v[128:131], v[144:147], v[72:87]
    v_mfma_f32_16x16x32_bf16 v[88:91], v[92:95], v[144:147], v[88:91]
    v_mfma_f32_32x32x16_bf16 v[40:55], v[132:135], v[148:151], v[40:55]
    v_mfma_f32_32x32x16_bf16 v[56:71], v[136:139], v[148:151], v[56:71]
    v_mfma_f32_32x32x16_bf16 v[72:87], v[140:143], v[148:151], v[72:87]
    v_mfma_f32_16x16x32_bf16 v[88:91], v[92:95], v[148:151], v[88:91]
    s_nop 15
    s_nop 15
    ds_read_b128 v[96:99], v4 offset:24576
    ds_read_b128 v[100:103], v5 offset:24576
    ds_read_b128 v[104:107], v4 offset:24640
    ds_read_b128 v[108:111], v5 offset:24640
    ds_read_b128 v[112:115], v4 offset:24704
    ds_read_b128 v[116:119], v5 offset:24704
    s_waitcnt lgkmcnt(0)
    ds_read_b64_tr_b16 v[120:121], v6 offset:24576
    ds_read_b64_tr_b16 v[122:123], v7 offset:24576
    ds_read_b64_tr_b16 v[124:125], v6 offset:24640
    ds_read_b64_tr_b16 v[126:127], v7 offset:24640
    ds_read_b64_tr_b16 v[128:129], v6 offset:24704
    ds_read_b64_tr_b16 v[130:131], v7 offset:24704
    ds_read_b64_tr_b16 v[132:133], v6 offset:27648
    ds_read_b64_tr_b16 v[134:135], v7 offset:27648
    ds_read_b64_tr_b16 v[136:137], v6 offset:27712
    ds_read_b64_tr_b16 v[138:139], v7 offset:27712
    ds_read_b64_tr_b16 v[140:141], v6 offset:27776
    ds_read_b64_tr_b16 v[142:143], v7 offset:27776
    v_mfma_f32_32x32x16_bf16 v[144:159], v[96:99], v[16:19], 0
    v_mfma_f32_32x32x16_bf16 v[144:159], v[100:103], v[20:23], v[144:159]
    v_mfma_f32_32x32x16_bf16 v[144:159], v[104:107], v[24:27], v[144:159]
    v_mfma_f32_32x32x16_bf16 v[144:159], v[108:111], v[28:31], v[144:159]
    v_mfma_f32_32x32x16_bf16 v[144:159], v[112:115], v[32:35], v[144:159]
    v_mfma_f32_32x32x16_bf16 v[144:159], v[116:119], v[36:39], v[144:159]
    s_nop 15
    s_nop 15
    v_max3_f32 v161, v144, v145, v146
    v_max3_f32 v161, v161, v147, v148
    v_max3_f32 v161, v161, v149, v150
    v_max3_f32 v161, v161, v151, v152
    v_max3_f32 v161, v161, v153, v154
    v_max3_f32 v161, v161, v155, v156
    v_max3_f32 v161, v161, v157, v158
    v_max_f32 v161, v161, v159
    v_mov_b32 v162, v161
    s_nop 1
    v_permlane32_swap_b32 v161, v162
    s_nop 1
    v_max_f32 v161, v161, v162
    v_max_f32 v161, v161, v160
    v_sub_f32 v164, v160, v161
    v_exp_f32 v164, v164
    v_mov_b32 v160, v161
    s_nop 1
    v_mov_b32 v165, v164
    v_mov_b32 v166, v164
    s_nop 1
    v_permlane16_swap_b32 v165, v166
    s_nop 1
    v_mul_f32 v40, v40, v164
    v_mul_f32 v41, v41, v164
    v_mul_f32 v42, v42, v164
    v_mul_f32 v43, v43, v164
    v_mul_f32 v44, v44, v164
    v_mul_f32 v45, v45, v164
    v_mul_f32 v46, v46, v164
    v_mul_f32 v47, v47, v164
    v_mul_f32 v48, v48, v164
    v_mul_f32 v49, v49, v164
    v_mul_f32 v50, v50, v164
    v_mul_f32 v51, v51, v164
    v_mul_f32 v52, v52, v164
    v_mul_f32 v53, v53, v164
    v_mul_f32 v54, v54, v164
    v_mul_f32 v55, v55, v164
    v_mul_f32 v56, v56, v164
    v_mul_f32 v57, v57, v164
    v_mul_f32 v58, v58, v164
    v_mul_f32 v59, v59, v164
    v_mul_f32 v60, v60, v164
    v_mul_f32 v61, v61, v164
    v_mul_f32 v62, v62, v164
    v_mul_f32 v63, v63, v164
    v_mul_f32 v64, v64, v164
    v_mul_f32 v65, v65, v164
    v_mul_f32 v66, v66, v164
    v_mul_f32 v67, v67, v164
    v_mul_f32 v68, v68, v164
    v_mul_f32 v69, v69, v164
    v_mul_f32 v70, v70, v164
    v_mul_f32 v71, v71, v164
    v_mul_f32 v72, v72, v164
    v_mul_f32 v73, v73, v164
    v_mul_f32 v74, v74, v164
    v_mul_f32 v75, v75, v164
    v_mul_f32 v76, v76, v164
    v_mul_f32 v77, v77, v164
    v_mul_f32 v78, v78, v164
    v_mul_f32 v79, v79, v164
    v_mul_f32 v80, v80, v164
    v_mul_f32 v81, v81, v164
    v_mul_f32 v82, v82, v164
    v_mul_f32 v83, v83, v164
    v_mul_f32 v84, v84, v164
    v_mul_f32 v85, v85, v164
    v_mul_f32 v86, v86, v164
    v_mul_f32 v87, v87, v164
    v_mul_f32 v88, v88, v165
    v_mul_f32 v89, v89, v166
    v_mul_f32 v90, v90, v165
    v_mul_f32 v91, v91, v166
    v_sub_f32 v144, v144, v160
    v_sub_f32 v145, v145, v160
    v_sub_f32 v146, v146, v160
    v_sub_f32 v147, v147, v160
    v_sub_f32 v148, v148, v160
    v_sub_f32 v149, v149, v160
    v_sub_f32 v150, v150, v160
    v_sub_f32 v151, v151, v160
    v_sub_f32 v152, v152, v160
    v_sub_f32 v153, v153, v160
    v_sub_f32 v154, v154, v160
    v_sub_f32 v155, v155, v160
    v_sub_f32 v156, v156, v160
    v_sub_f32 v157, v157, v160
    v_sub_f32 v158, v158, v160
    v_sub_f32 v159, v159, v160
    v_exp_f32 v144, v144
    v_exp_f32 v145, v145
    v_exp_f32 v146, v146
    v_exp_f32 v147, v147
    v_exp_f32 v148, v148
    v_exp_f32 v149, v149
    v_exp_f32 v150, v150
    v_exp_f32 v151, v151
    v_exp_f32 v152, v152
    v_exp_f32 v153, v153
    v_exp_f32 v154, v154
    v_exp_f32 v155, v155
    v_exp_f32 v156, v156
    v_exp_f32 v157, v157
    v_exp_f32 v158, v158
    v_exp_f32 v159, v159
    s_nop 1
    v_cvt_pk_bf16_f32 v144, v144, v145
    v_cvt_pk_bf16_f32 v145, v146, v147
    v_cvt_pk_bf16_f32 v146, v148, v149
    v_cvt_pk_bf16_f32 v147, v150, v151
    v_cvt_pk_bf16_f32 v148, v152, v153
    v_cvt_pk_bf16_f32 v149, v154, v155
    v_cvt_pk_bf16_f32 v150, v156, v157
    v_cvt_pk_bf16_f32 v151, v158, v159
    s_waitcnt lgkmcnt(0)
    s_nop 1
    v_mfma_f32_32x32x16_bf16 v[40:55], v[120:123], v[144:147], v[40:55]
    v_mfma_f32_32x32x16_bf16 v[56:71], v[124:127], v[144:147], v[56:71]
    v_mfma_f32_32x32x16_bf16 v[72:87], v[128:131], v[144:147], v[72:87]
    v_mfma_f32_16x16x32_bf16 v[88:91], v[92:95], v[144:147], v[88:91]
    v_mfma_f32_32x32x16_bf16 v[40:55], v[132:135], v[148:151], v[40:55]
    v_mfma_f32_32x32x16_bf16 v[56:71], v[136:139], v[148:151], v[56:71]
    v_mfma_f32_32x32x16_bf16 v[72:87], v[140:143], v[148:151], v[72:87]
    v_mfma_f32_16x16x32_bf16 v[88:91], v[92:95], v[148:151], v[88:91]
    s_nop 15
    s_nop 15
    ds_read_b64_tr_b16 v[200:201], v8 offset:0
    ds_read_b64_tr_b16 v[202:203], v8 offset:384
    ds_read_b64_tr_b16 v[212:213], v8 offset:32
    ds_read_b64_tr_b16 v[214:215], v8 offset:416
    ds_read_b64_tr_b16 v[204:205], v8 offset:1536
    ds_read_b64_tr_b16 v[206:207], v8 offset:1920
    ds_read_b64_tr_b16 v[216:217], v8 offset:1568
    ds_read_b64_tr_b16 v[218:219], v8 offset:1952
    ds_read_b64_tr_b16 v[208:209], v8 offset:3072
    ds_read_b64_tr_b16 v[210:211], v8 offset:3456
    ds_read_b64_tr_b16 v[220:221], v8 offset:3104
    ds_read_b64_tr_b16 v[222:223], v8 offset:3488
    s_waitcnt lgkmcnt(0)
    s_branch Z_epi
Z_r3s:
    v_mov_b32 v10, 163328
Z_r3w:
    ds_read_b32 v252, v10
    s_waitcnt lgkmcnt(0)
    v_readfirstlane_b32 s50, v252
    s_nop 3
    s_cmp_lt_u32 s50, 4
    s_cbranch_scc1 Z_r3w
    ds_read_b128 v[96:99], v4 offset:0
    ds_read_b128 v[100:103], v5 offset:0
    ds_read_b128 v[104:107], v4 offset:64
    ds_read_b128 v[108:111], v5 offset:64
    ds_read_b128 v[112:115], v4 offset:128
    ds_read_b128 v[116:119], v5 offset:128
    s_waitcnt lgkmcnt(0)
    ds_read_b64_tr_b16 v[120:121], v6 offset:0
    ds_read_b64_tr_b16 v[122:123], v7 offset:0
    ds_read_b64_tr_b16 v[124:125], v6 offset:64
    ds_read_b64_tr_b16 v[126:127], v7 offset:64
    ds_read_b64_tr_b16 v[128:129], v6 offset:128
    ds_read_b64_tr_b16 v[130:131], v7 offset:128
    ds_read_b64_tr_b16 v[132:133], v6 offset:3072
    ds_read_b64_tr_b16 v[134:135], v7 offset:3072
    ds_read_b64_tr_b16 v[136:137], v6 offset:3136
    ds_read_b64_tr_b16 v[138:139], v7 offset:3136
    ds_read_b64_tr_b16 v[140:141], v6 offset:3200
    ds_read_b64_tr_b16 v[142:143], v7 offset:3200
    v_mfma_f32_32x32x16_bf16 v[144:159], v[96:99], v[16:19], 0
    v_mfma_f32_32x32x16_bf16 v[144:159], v[100:103], v[20:23], v[144:159]
    v_mfma_f32_32x32x16_bf16 v[144:159], v[104:107], v[24:27], v[144:159]
    v_mfma_f32_32x32x16_bf16 v[144:159], v[108:111], v[28:31], v[144:159]
    v_mfma_f32_32x32x16_bf16 v[144:159], v[112:115], v[32:35], v[144:159]
    v_mfma_f32_32x32x16_bf16 v[144:159], v[116:119], v[36:39], v[144:159]
    s_nop 15
    s_nop 15
    v_max3_f32 v161, v144, v145, v146
    v_max3_f32 v161, v161, v147, v148
    v_max3_f32 v161, v161, v149, v150
    v_max3_f32 v161, v161, v151, v152
    v_max3_f32 v161, v161, v153, v154
    v_max3_f32 v161, v161, v155, v156
    v_max3_f32 v161, v161, v157, v158
    v_max_f32 v161, v161, v159
    v_mov_b32 v162, v161
    s_nop 1
    v_permlane32_swap_b32 v161, v162
    s_nop 1
    v_max_f32 v161, v161, v162
    v_max_f32 v161, v161, v160
    v_sub_f32 v164, v160, v161
    v_exp_f32 v164, v164
    v_mov_b32 v160, v161
    s_nop 1
    v_mov_b32 v165, v164
    v_mov_b32 v166, v164
    s_nop 1
    v_permlane16_swap_b32 v165, v166
    s_nop 1
    v_mul_f32 v40, v40, v164
    v_mul_f32 v41, v41, v164
    v_mul_f32 v42, v42, v164
    v_mul_f32 v43, v43, v164
    v_mul_f32 v44, v44, v164
    v_mul_f32 v45, v45, v164
    v_mul_f32 v46, v46, v164
    v_mul_f32 v47, v47, v164
    v_mul_f32 v48, v48, v164
    v_mul_f32 v49, v49, v164
    v_mul_f32 v50, v50, v164
    v_mul_f32 v51, v51, v164
    v_mul_f32 v52, v52, v164
    v_mul_f32 v53, v53, v164
    v_mul_f32 v54, v54, v164
    v_mul_f32 v55, v55, v164
    v_mul_f32 v56, v56, v164
    v_mul_f32 v57, v57, v164
    v_mul_f32 v58, v58, v164
    v_mul_f32 v59, v59, v164
    v_mul_f32 v60, v60, v164
    v_mul_f32 v61, v61, v164
    v_mul_f32 v62, v62, v164
    v_mul_f32 v63, v63, v164
    v_mul_f32 v64, v64, v164
    v_mul_f32 v65, v65, v164
    v_mul_f32 v66, v66, v164
    v_mul_f32 v67, v67, v164
    v_mul_f32 v68, v68, v164
    v_mul_f32 v69, v69, v164
    v_mul_f32 v70, v70, v164
    v_mul_f32 v71, v71, v164
    v_mul_f32 v72, v72, v164
    v_mul_f32 v73, v73, v164
    v_mul_f32 v74, v74, v164
    v_mul_f32 v75, v75, v164
    v_mul_f32 v76, v76, v164
    v_mul_f32 v77, v77, v164
    v_mul_f32 v78, v78, v164
    v_mul_f32 v79, v79, v164
    v_mul_f32 v80, v80, v164
    v_mul_f32 v81, v81, v164
    v_mul_f32 v82, v82, v164
    v_mul_f32 v83, v83, v164
    v_mul_f32 v84, v84, v164
    v_mul_f32 v85, v85, v164
    v_mul_f32 v86, v86, v164
    v_mul_f32 v87, v87, v164
    v_mul_f32 v88, v88, v165
    v_mul_f32 v89, v89, v166
    v_mul_f32 v90, v90, v165
    v_mul_f32 v91, v91, v166
    v_sub_f32 v144, v144, v160
    v_sub_f32 v145, v145, v160
    v_sub_f32 v146, v146, v160
    v_sub_f32 v147, v147, v160
    v_sub_f32 v148, v148, v160
    v_sub_f32 v149, v149, v160
    v_sub_f32 v150, v150, v160
    v_sub_f32 v151, v151, v160
    v_sub_f32 v152, v152, v160
    v_sub_f32 v153, v153, v160
    v_sub_f32 v154, v154, v160
    v_sub_f32 v155, v155, v160
    v_sub_f32 v156, v156, v160
    v_sub_f32 v157, v157, v160
    v_sub_f32 v158, v158, v160
    v_sub_f32 v159, v159, v160
    v_exp_f32 v144, v144
    v_exp_f32 v145, v145
    v_exp_f32 v146, v146
    v_exp_f32 v147, v147
    v_exp_f32 v148, v148
    v_exp_f32 v149, v149
    v_exp_f32 v150, v150
    v_exp_f32 v151, v151
    v_exp_f32 v152, v152
    v_exp_f32 v153, v153
    v_exp_f32 v154, v154
    v_exp_f32 v155, v155
    v_exp_f32 v156, v156
    v_exp_f32 v157, v157
    v_exp_f32 v158, v158
    v_exp_f32 v159, v159
    s_nop 1
    v_cvt_pk_bf16_f32 v144, v144, v145
    v_cvt_pk_bf16_f32 v145, v146, v147
    v_cvt_pk_bf16_f32 v146, v148, v149
    v_cvt_pk_bf16_f32 v147, v150, v151
    v_cvt_pk_bf16_f32 v148, v152, v153
    v_cvt_pk_bf16_f32 v149, v154, v155
    v_cvt_pk_bf16_f32 v150, v156, v157
    v_cvt_pk_bf16_f32 v151, v158, v159
    s_waitcnt lgkmcnt(0)
    s_nop 1
    v_mfma_f32_32x32x16_bf16 v[40:55], v[120:123], v[144:147], v[40:55]
    v_mfma_f32_32x32x16_bf16 v[56:71], v[124:127], v[144:147], v[56:71]
    v_mfma_f32_32x32x16_bf16 v[72:87], v[128:131], v[144:147], v[72:87]
    v_mfma_f32_16x16x32_bf16 v[88:91], v[92:95], v[144:147], v[88:91]
    v_mfma_f32_32x32x16_bf16 v[40:55], v[132:135], v[148:151], v[40:55]
    v_mfma_f32_32x32x16_bf16 v[56:71], v[136:139], v[148:151], v[56:71]
    v_mfma_f32_32x32x16_bf16 v[72:87], v[140:143], v[148:151], v[72:87]
    v_mfma_f32_16x16x32_bf16 v[88:91], v[92:95], v[148:151], v[88:91]
    s_nop 15
    s_nop 15
    v_add_u32 v4, 24576, v4
    v_add_u32 v5, 24576, v5
    v_add_u32 v6, 24576, v6
    v_add_u32 v7, 24576, v7
Z_r4w0:
    ds_read_b32 v252, v240
    s_waitcnt lgkmcnt(0)
    v_cmp_lt_u32 vcc, v252, v255
    s_cbranch_vccnz Z_r4w0
    s_setprio 3
    ds_read_b128 v[96:99], v4 offset:0
    ds_read_b128 v[100:103], v5 offset:0
    ds_read_b128 v[104:107], v4 offset:64
    ds_read_b128 v[108:111], v5 offset:64
    ds_read_b128 v[112:115], v4 offset:128
    ds_read_b128 v[116:119], v5 offset:128
    s_waitcnt lgkmcnt(0)
    ds_read_b64_tr_b16 v[120:121], v6 offset:0
    ds_read_b64_tr_b16 v[122:123], v7 offset:0
    ds_read_b64_tr_b16 v[124:125], v6 offset:64
    ds_read_b64_tr_b16 v[126:127], v7 offset:64
    ds_read_b64_tr_b16 v[128:129], v6 offset:128
    ds_read_b64_tr_b16 v[130:131], v7 offset:128
    ds_read_b64_tr_b16 v[132:133], v6 offset:3072
    ds_read_b64_tr_b16 v[134:135], v7 offset:3072
    ds_read_b64_tr_b16 v[136:137], v6 offset:3136
    ds_read_b64_tr_b16 v[138:139], v7 offset:3136
    ds_read_b64_tr_b16 v[140:141], v6 offset:3200
    ds_read_b64_tr_b16 v[142:143], v7 offset:3200
    v_mfma_f32_32x32x16_bf16 v[144:159], v[96:99], v[16:19], 0
    v_mfma_f32_32x32x16_bf16 v[144:159], v[100:103], v[20:23], v[144:159]
    v_mfma_f32_32x32x16_bf16 v[144:159], v[104:107], v[24:27], v[144:159]
    v_mfma_f32_32x32x16_bf16 v[144:159], v[108:111], v[28:31], v[144:159]
    v_mfma_f32_32x32x16_bf16 v[144:159], v[112:115], v[32:35], v[144:159]
    v_mfma_f32_32x32x16_bf16 v[144:159], v[116:119], v[36:39], v[144:159]
    s_nop 15
    s_nop 15
    v_max3_f32 v161, v144, v145, v146
    v_max3_f32 v161, v161, v147, v148
    v_max3_f32 v161, v161, v149, v150
    v_max3_f32 v161, v161, v151, v152
    v_max3_f32 v161, v161, v153, v154
    v_max3_f32 v161, v161, v155, v156
    v_max3_f32 v161, v161, v157, v158
    v_max_f32 v161, v161, v159
    v_mov_b32 v162, v161
    s_nop 1
    v_permlane32_swap_b32 v161, v162
    s_nop 1
    v_max_f32 v161, v161, v162
    v_max_f32 v161, v161, v160
    v_sub_f32 v164, v160, v161
    v_exp_f32 v164, v164
    v_mov_b32 v160, v161
    s_nop 1
    v_mov_b32 v165, v164
    v_mov_b32 v166, v164
    s_nop 1
    v_permlane16_swap_b32 v165, v166
    s_nop 1
    v_mul_f32 v40, v40, v164
    v_mul_f32 v41, v41, v164
    v_mul_f32 v42, v42, v164
    v_mul_f32 v43, v43, v164
    v_mul_f32 v44, v44, v164
    v_mul_f32 v45, v45, v164
    v_mul_f32 v46, v46, v164
    v_mul_f32 v47, v47, v164
    v_mul_f32 v48, v48, v164
    v_mul_f32 v49, v49, v164
    v_mul_f32 v50, v50, v164
    v_mul_f32 v51, v51, v164
    v_mul_f32 v52, v52, v164
    v_mul_f32 v53, v53, v164
    v_mul_f32 v54, v54, v164
    v_mul_f32 v55, v55, v164
    v_mul_f32 v56, v56, v164
    v_mul_f32 v57, v57, v164
    v_mul_f32 v58, v58, v164
    v_mul_f32 v59, v59, v164
    v_mul_f32 v60, v60, v164
    v_mul_f32 v61, v61, v164
    v_mul_f32 v62, v62, v164
    v_mul_f32 v63, v63, v164
    v_mul_f32 v64, v64, v164
    v_mul_f32 v65, v65, v164
    v_mul_f32 v66, v66, v164
    v_mul_f32 v67, v67, v164
    v_mul_f32 v68, v68, v164
    v_mul_f32 v69, v69, v164
    v_mul_f32 v70, v70, v164
    v_mul_f32 v71, v71, v164
    v_mul_f32 v72, v72, v164
    v_mul_f32 v73, v73, v164
    v_mul_f32 v74, v74, v164
    v_mul_f32 v75, v75, v164
    v_mul_f32 v76, v76, v164
    v_mul_f32 v77, v77, v164
    v_mul_f32 v78, v78, v164
    v_mul_f32 v79, v79, v164
    v_mul_f32 v80, v80, v164
    v_mul_f32 v81, v81, v164
    v_mul_f32 v82, v82, v164
    v_mul_f32 v83, v83, v164
    v_mul_f32 v84, v84, v164
    v_mul_f32 v85, v85, v164
    v_mul_f32 v86, v86, v164
    v_mul_f32 v87, v87, v164
    v_mul_f32 v88, v88, v165
    v_mul_f32 v89, v89, v166
    v_mul_f32 v90, v90, v165
    v_mul_f32 v91, v91, v166
    v_sub_f32 v144, v144, v160
    v_sub_f32 v145, v145, v160
    v_sub_f32 v146, v146, v160
    v_sub_f32 v147, v147, v160
    v_sub_f32 v148, v148, v160
    v_sub_f32 v149, v149, v160
    v_sub_f32 v150, v150, v160
    v_sub_f32 v151, v151, v160
    v_sub_f32 v152, v152, v160
    v_sub_f32 v153, v153, v160
    v_sub_f32 v154, v154, v160
    v_sub_f32 v155, v155, v160
    v_sub_f32 v156, v156, v160
    v_sub_f32 v157, v157, v160
    v_sub_f32 v158, v158, v160
    v_sub_f32 v159, v159, v160
    v_exp_f32 v144, v144
    v_exp_f32 v145, v145
    v_exp_f32 v146, v146
    v_exp_f32 v147, v147
    v_exp_f32 v148, v148
    v_exp_f32 v149, v149
    v_exp_f32 v150, v150
    v_exp_f32 v151, v151
    v_exp_f32 v152, v152
    v_exp_f32 v153, v153
    v_exp_f32 v154, v154
    v_exp_f32 v155, v155
    v_exp_f32 v156, v156
    v_exp_f32 v157, v157
    v_exp_f32 v158, v158
    v_exp_f32 v159, v159
    s_nop 1
    v_cvt_pk_bf16_f32 v144, v144, v145
    v_cvt_pk_bf16_f32 v145, v146, v147
    v_cvt_pk_bf16_f32 v146, v148, v149
    v_cvt_pk_bf16_f32 v147, v150, v151
    v_cvt_pk_bf16_f32 v148, v152, v153
    v_cvt_pk_bf16_f32 v149, v154, v155
    v_cvt_pk_bf16_f32 v150, v156, v157
    v_cvt_pk_bf16_f32 v151, v158, v159
    s_waitcnt lgkmcnt(0)
    s_nop 1
    v_mfma_f32_32x32x16_bf16 v[40:55], v[120:123], v[144:147], v[40:55]
    v_mfma_f32_32x32x16_bf16 v[56:71], v[124:127], v[144:147], v[56:71]
    v_mfma_f32_32x32x16_bf16 v[72:87], v[128:131], v[144:147], v[72:87]
    v_mfma_f32_16x16x32_bf16 v[88:91], v[92:95], v[144:147], v[88:91]
    v_mfma_f32_32x32x16_bf16 v[40:55], v[132:135], v[148:151], v[40:55]
    v_mfma_f32_32x32x16_bf16 v[56:71], v[136:139], v[148:151], v[56:71]
    v_mfma_f32_32x32x16_bf16 v[72:87], v[140:143], v[148:151], v[72:87]
    v_mfma_f32_16x16x32_bf16 v[88:91], v[92:95], v[148:151], v[88:91]
    s_nop 15
    s_nop 15
    ds_read_b64_tr_b16 v[200:201], v8 offset:0
    ds_read_b64_tr_b16 v[202:203], v8 offset:384
    ds_read_b64_tr_b16 v[212:213], v8 offset:32
    ds_read_b64_tr_b16 v[214:215], v8 offset:416
    ds_read_b64_tr_b16 v[204:205], v8 offset:1536
    ds_read_b64_tr_b16 v[206:207], v8 offset:1920
    ds_read_b64_tr_b16 v[216:217], v8 offset:1568
    ds_read_b64_tr_b16 v[218:219], v8 offset:1952
    ds_read_b64_tr_b16 v[208:209], v8 offset:3072
    ds_read_b64_tr_b16 v[210:211], v8 offset:3456
    ds_read_b64_tr_b16 v[220:221], v8 offset:3104
    ds_read_b64_tr_b16 v[222:223], v8 offset:3488
    s_waitcnt lgkmcnt(0)
Z_epi:
    s_lshl_b32 s41, s40, 7
    s_add_u32 s41, s41, 162816
    v_and_b32 v161, 31, v1
    v_lshlrev_b32 v161, 2, v161
    v_add_u32 v161, s41, v161
    ds_write_b32 v161, v160
    s_waitcnt lgkmcnt(0)
    v_mov_b32 v162, 163432
    v_mov_b32 v163, 1
    s_mov_b64 exec, 1
    ds_add_rtn_u32 v163, v162, v163
    s_mov_b64 exec, -1
    s_waitcnt lgkmcnt(0)
    v_readfirstlane_b32 s50, v163
    s_nop 3
    s_cmp_ge_u32 s50, 3
    s_cbranch_scc1 Z_sy18_ok
Z_sy18_spin:
    ds_read_b32 v163, v162
    s_waitcnt lgkmcnt(0)
    v_readfirstlane_b32 s50, v163
    s_nop 3
    s_cmp_lt_u32 s50, 4
    s_cbranch_scc1 Z_sy18_spin
Z_sy18_ok:
    v_xor_b32 v161, 320, v161
    ds_read_b32 v162, v161
    s_waitcnt lgkmcnt(0)
    v_max_f32 v162, v162, v160
    v_sub_f32 v164, v160, v162
    v_exp_f32 v164, v164
    v_mov_b32 v160, v162
    s_nop 1
    v_mov_b32 v165, v164
    v_mov_b32 v166, v164
    s_nop 1
    v_permlane16_swap_b32 v165, v166
    s_nop 1
    v_mul_f32 v40, v40, v164
    v_mul_f32 v41, v41, v164
    v_mul_f32 v42, v42, v164
    v_mul_f32 v43, v43, v164
    v_mul_f32 v44, v44, v164
    v_mul_f32 v45, v45, v164
    v_mul_f32 v46, v46, v164
    v_mul_f32 v47, v47, v164
    v_mul_f32 v48, v48, v164
    v_mul_f32 v49, v49, v164
    v_mul_f32 v50, v50, v164
    v_mul_f32 v51, v51, v164
    v_mul_f32 v52, v52, v164
    v_mul_f32 v53, v53, v164
    v_mul_f32 v54, v54, v164
    v_mul_f32 v55, v55, v164
    v_mul_f32 v56, v56, v164
    v_mul_f32 v57, v57, v164
    v_mul_f32 v58, v58, v164
    v_mul_f32 v59, v59, v164
    v_mul_f32 v60, v60, v164
    v_mul_f32 v61, v61, v164
    v_mul_f32 v62, v62, v164
    v_mul_f32 v63, v63, v164
    v_mul_f32 v64, v64, v164
    v_mul_f32 v65, v65, v164
    v_mul_f32 v66, v66, v164
    v_mul_f32 v67, v67, v164
    v_mul_f32 v68, v68, v164
    v_mul_f32 v69, v69, v164
    v_mul_f32 v70, v70, v164
    v_mul_f32 v71, v71, v164
    v_mul_f32 v72, v72, v164
    v_mul_f32 v73, v73, v164
    v_mul_f32 v74, v74, v164
    v_mul_f32 v75, v75, v164
    v_mul_f32 v76, v76, v164
    v_mul_f32 v77, v77, v164
    v_mul_f32 v78, v78, v164
    v_mul_f32 v79, v79, v164
    v_mul_f32 v80, v80, v164
    v_mul_f32 v81, v81, v164
    v_mul_f32 v82, v82, v164
    v_mul_f32 v83, v83, v164
    v_mul_f32 v84, v84, v164
    v_mul_f32 v85, v85, v164
    v_mul_f32 v86, v86, v164
    v_mul_f32 v87, v87, v164
    v_mul_f32 v88, v88, v165
    v_mul_f32 v89, v89, v166
    v_mul_f32 v90, v90, v165
    v_mul_f32 v91, v91, v166
    v_mov_b32 v161, s47
    s_mov_b32 exec_lo, 0
    s_mov_b32 exec_hi, 0xffff
    buffer_store_dwordx2 v[160:161], v254, s[36:39], 0 offen sc1
    s_mov_b64 exec, -1
    v_cndmask_b32 v248, v88, v89, s[44:45]
    v_and_b32 v250, s46, v248
    v_sub_f32 v248, v248, v250
    v_cndmask_b32 v248, v250, v248, s[52:53]
    v_bfi_b32 v248, s46, v248, v249
    ds_write_b32 v244, v248 offset:3072
    v_cvt_pk_bf16_f32 v96, v40, v41
    v_cvt_pk_bf16_f32 v97, v42, v43
    v_cvt_pk_bf16_f32 v98, v44, v45
    v_cvt_pk_bf16_f32 v99, v46, v47
    v_cvt_pk_bf16_f32 v100, v48, v49
    v_cvt_pk_bf16_f32 v101, v50, v51
    v_cvt_pk_bf16_f32 v102, v52, v53
    v_cvt_pk_bf16_f32 v103, v54, v55
    v_cvt_pk_bf16_f32 v104, v56, v57
    v_cvt_pk_bf16_f32 v105, v58, v59
    v_permlane16_swap_b32 v96, v100
    v_permlane16_swap_b32 v97, v101
    v_permlane16_swap_b32 v98, v102
    v_permlane16_swap_b32 v99, v103
    v_cvt_pk_bf16_f32 v106, v60, v61
    v_cvt_pk_bf16_f32 v107, v62, v63
    ds_write_b128 v242, v[100:103] offset:0
    v_cvt_pk_bf16_f32 v108, v64, v65
    v_cvt_pk_bf16_f32 v109, v66, v67
    v_cvt_pk_bf16_f32 v110, v68, v69
    v_cvt_pk_bf16_f32 v111, v70, v71
    v_cvt_pk_bf16_f32 v112, v72, v73
    v_cvt_pk_bf16_f32 v113, v74, v75
    v_permlane16_swap_b32 v104, v108
    v_permlane16_swap_b32 v105, v109
    v_permlane16_swap_b32 v106, v110
    v_permlane16_swap_b32 v107, v111
    v_cvt_pk_bf16_f32 v114, v76, v77
    v_cvt_pk_bf16_f32 v115, v78, v79
    ds_write_b128 v242, v[108:111] offset:1024
    v_cvt_pk_bf16_f32 v116, v80, v81
    v_cvt_pk_bf16_f32 v117, v82, v83
    v_cvt_pk_bf16_f32 v118, v84, v85
    v_cvt_pk_bf16_f32 v119, v86, v87
    s_nop 0
    v_permlane16_swap_b32 v112, v116
    v_permlane16_swap_b32 v113, v117
    v_permlane16_swap_b32 v114, v118
    v_permlane16_swap_b32 v115, v119
    s_nop 0
    ds_write_b128 v242, v[116:119] offset:2048
    ds_write_b32 v0, v251
    v_mfma_f32_16x16x32_bf16 v[120:123], v[200:203], v[96:99], 0
    v_mfma_f32_16x16x32_bf16 v[124:127], v[212:215], v[96:99], 0
    ds_read_b32 v15, v243
    ds_read_b128 v[128:131], v241 offset:3072
    ds_read_b128 v[132:135], v241 offset:4096
    ds_read_b128 v[136:139], v241 offset:5120
    ds_read_b32 v140, v245 offset:6144
    v_mfma_f32_16x16x32_bf16 v[120:123], v[204:207], v[104:107], v[120:123]
    v_mfma_f32_16x16x32_bf16 v[124:127], v[216:219], v[104:107], v[124:127]
    v_mfma_f32_16x16x32_bf16 v[120:123], v[208:211], v[112:115], v[120:123]
    v_mfma_f32_16x16x32_bf16 v[124:127], v[220:223], v[112:115], v[124:127]
Z_xw:
    s_waitcnt lgkmcnt(4)
    v_cmp_eq_u32 vcc, 0, v15
    s_cbranch_vccnz Z_xr
    s_waitcnt lgkmcnt(3)
    v_mfma_f32_16x16x32_bf16 v[120:123], v[200:203], v[128:131], v[120:123]
    v_mfma_f32_16x16x32_bf16 v[124:127], v[212:215], v[128:131], v[124:127]
    s_waitcnt lgkmcnt(2)
    v_mfma_f32_16x16x32_bf16 v[120:123], v[204:207], v[132:135], v[120:123]
    v_mfma_f32_16x16x32_bf16 v[124:127], v[216:219], v[132:135], v[124:127]
    s_waitcnt lgkmcnt(1)
    v_mfma_f32_16x16x32_bf16 v[120:123], v[208:211], v[136:139], v[120:123]
    v_mfma_f32_16x16x32_bf16 v[124:127], v[220:223], v[136:139], v[124:127]
    s_waitcnt lgkmcnt(0)
    v_cndmask_b32 v248, v248, v140, s[44:45]
    s_nop 1
    v_cvt_pk_bf16_f32 v120, v120, v121
    v_cvt_pk_bf16_f32 v121, v122, v123
    v_mov_b32 v123, v248
    s_nop 0
    v_cvt_pk_bf16_f32 v122, v124, v125
    v_cvt_pk_bf16_f32 v124, v126, v127
    s_nop 1
    v_permlane32_swap_b32 v122, v124
    buffer_store_dwordx4 v[120:123], v3, s[36:39], 0 offen sc1
    s_cmp_ge_u32 s2, 16
    s_cbranch_scc1 L_exit
    v_mov_b32 v14, 163388
    v_mov_b32 v15, 0x101
    s_mov_b64 exec, 1
    ds_add_u32 v14, v15
    s_mov_b64 exec, -1
    s_setprio 0
    s_branch Z_comb
Z_xr:
    ds_read_b32 v15, v243
    ds_read_b128 v[128:131], v241 offset:3072
    ds_read_b128 v[132:135], v241 offset:4096
    ds_read_b128 v[136:139], v241 offset:5120
    ds_read_b32 v140, v245 offset:6144
    s_branch Z_xw
Z_getnonce:
    s_memrealtime s[50:51]
    s_waitcnt lgkmcnt(0)
    s_or_b32 s47, s50, 1
    v_mov_b32 v248, s47
    v_mov_b32 v249, 0
    v_mov_b32 v250, 0
    s_mov_b64 exec, 1
    global_atomic_cmpswap v248, v250, v[248:249], s[24:25] sc0 sc1
    s_mov_b64 exec, -1
    s_waitcnt vmcnt(0)
    v_readfirstlane_b32 s50, v248
    s_nop 3
    s_cmp_eq_u32 s50, 0
    s_cselect_b32 s47, s47, s50
    s_branch Z_getnonce_d
Z_wait:
Z_blk:
    ds_read_b64 v[252:253], v10
    s_waitcnt lgkmcnt(0)
    v_min_u32 v252, v252, v253
    s_nop 0
    v_readfirstlane_b32 s50, v252
    s_nop 3
    s_cmp_lt_u32 s50, s43
    s_cbranch_scc1 Z_wait
    ds_read_b128 v[96:99], v4 offset:0
    ds_read_b128 v[100:103], v5 offset:0
    ds_read_b128 v[104:107], v4 offset:64
    ds_read_b128 v[108:111], v5 offset:64
    ds_read_b128 v[112:115], v4 offset:128
    ds_read_b128 v[116:119], v5 offset:128
    s_waitcnt lgkmcnt(0)
    ds_read_b64_tr_b16 v[120:121], v6 offset:0
    ds_read_b64_tr_b16 v[122:123], v7 offset:0
    ds_read_b64_tr_b16 v[124:125], v6 offset:64
    ds_read_b64_tr_b16 v[126:127], v7 offset:64
    ds_read_b64_tr_b16 v[128:129], v6 offset:128
    ds_read_b64_tr_b16 v[130:131], v7 offset:128
    ds_read_b64_tr_b16 v[132:133], v6 offset:3072
    ds_read_b64_tr_b16 v[134:135], v7 offset:3072
    ds_read_b64_tr_b16 v[136:137], v6 offset:3136
    ds_read_b64_tr_b16 v[138:139], v7 offset:3136
    ds_read_b64_tr_b16 v[140:141], v6 offset:3200
    ds_read_b64_tr_b16 v[142:143], v7 offset:3200
    v_mfma_f32_32x32x16_bf16 v[144:159], v[96:99], v[16:19], 0
    v_mfma_f32_32x32x16_bf16 v[144:159], v[100:103], v[20:23], v[144:159]
    v_mfma_f32_32x32x16_bf16 v[144:159], v[104:107], v[24:27], v[144:159]
    v_mfma_f32_32x32x16_bf16 v[144:159], v[108:111], v[28:31], v[144:159]
    v_mfma_f32_32x32x16_bf16 v[144:159], v[112:115], v[32:35], v[144:159]
    v_mfma_f32_32x32x16_bf16 v[144:159], v[116:119], v[36:39], v[144:159]
    s_nop 15
    s_nop 15
    v_max3_f32 v161, v144, v145, v146
    v_max3_f32 v161, v161, v147, v148
    v_max3_f32 v161, v161, v149, v150
    v_max3_f32 v161, v161, v151, v152
    v_max3_f32 v161, v161, v153, v154
    v_max3_f32 v161, v161, v155, v156
    v_max3_f32 v161, v161, v157, v158
    v_max_f32 v161, v161, v159
    v_mov_b32 v162, v161
    s_nop 1
    v_permlane32_swap_b32 v161, v162
    s_nop 1
    v_max_f32 v161, v161, v162
    v_max_f32 v161, v161, v160
    v_sub_f32 v164, v160, v161
    v_exp_f32 v164, v164
    v_mov_b32 v160, v161
    s_nop 1
    v_mov_b32 v165, v164
    v_mov_b32 v166, v164
    s_nop 1
    v_permlane16_swap_b32 v165, v166
    s_nop 1
    v_mul_f32 v40, v40, v164
    v_mul_f32 v41, v41, v164
    v_mul_f32 v42, v42, v164
    v_mul_f32 v43, v43, v164
    v_mul_f32 v44, v44, v164
    v_mul_f32 v45, v45, v164
    v_mul_f32 v46, v46, v164
    v_mul_f32 v47, v47, v164
    v_mul_f32 v48, v48, v164
    v_mul_f32 v49, v49, v164
    v_mul_f32 v50, v50, v164
    v_mul_f32 v51, v51, v164
    v_mul_f32 v52, v52, v164
    v_mul_f32 v53, v53, v164
    v_mul_f32 v54, v54, v164
    v_mul_f32 v55, v55, v164
    v_mul_f32 v56, v56, v164
    v_mul_f32 v57, v57, v164
    v_mul_f32 v58, v58, v164
    v_mul_f32 v59, v59, v164
    v_mul_f32 v60, v60, v164
    v_mul_f32 v61, v61, v164
    v_mul_f32 v62, v62, v164
    v_mul_f32 v63, v63, v164
    v_mul_f32 v64, v64, v164
    v_mul_f32 v65, v65, v164
    v_mul_f32 v66, v66, v164
    v_mul_f32 v67, v67, v164
    v_mul_f32 v68, v68, v164
    v_mul_f32 v69, v69, v164
    v_mul_f32 v70, v70, v164
    v_mul_f32 v71, v71, v164
    v_mul_f32 v72, v72, v164
    v_mul_f32 v73, v73, v164
    v_mul_f32 v74, v74, v164
    v_mul_f32 v75, v75, v164
    v_mul_f32 v76, v76, v164
    v_mul_f32 v77, v77, v164
    v_mul_f32 v78, v78, v164
    v_mul_f32 v79, v79, v164
    v_mul_f32 v80, v80, v164
    v_mul_f32 v81, v81, v164
    v_mul_f32 v82, v82, v164
    v_mul_f32 v83, v83, v164
    v_mul_f32 v84, v84, v164
    v_mul_f32 v85, v85, v164
    v_mul_f32 v86, v86, v164
    v_mul_f32 v87, v87, v164
    v_mul_f32 v88, v88, v165
    v_mul_f32 v89, v89, v166
    v_mul_f32 v90, v90, v165
    v_mul_f32 v91, v91, v166
    v_sub_f32 v144, v144, v160
    v_sub_f32 v145, v145, v160
    v_sub_f32 v146, v146, v160
    v_sub_f32 v147, v147, v160
    v_sub_f32 v148, v148, v160
    v_sub_f32 v149, v149, v160
    v_sub_f32 v150, v150, v160
    v_sub_f32 v151, v151, v160
    v_sub_f32 v152, v152, v160
    v_sub_f32 v153, v153, v160
    v_sub_f32 v154, v154, v160
    v_sub_f32 v155, v155, v160
    v_sub_f32 v156, v156, v160
    v_sub_f32 v157, v157, v160
    v_sub_f32 v158, v158, v160
    v_sub_f32 v159, v159, v160
    v_exp_f32 v144, v144
    v_exp_f32 v145, v145
    v_exp_f32 v146, v146
    v_exp_f32 v147, v147
    v_exp_f32 v148, v148
    v_exp_f32 v149, v149
    v_exp_f32 v150, v150
    v_exp_f32 v151, v151
    v_exp_f32 v152, v152
    v_exp_f32 v153, v153
    v_exp_f32 v154, v154
    v_exp_f32 v155, v155
    v_exp_f32 v156, v156
    v_exp_f32 v157, v157
    v_exp_f32 v158, v158
    v_exp_f32 v159, v159
    s_nop 1
    v_cvt_pk_bf16_f32 v144, v144, v145
    v_cvt_pk_bf16_f32 v145, v146, v147
    v_cvt_pk_bf16_f32 v146, v148, v149
    v_cvt_pk_bf16_f32 v147, v150, v151
    v_cvt_pk_bf16_f32 v148, v152, v153
    v_cvt_pk_bf16_f32 v149, v154, v155
    v_cvt_pk_bf16_f32 v150, v156, v157
    v_cvt_pk_bf16_f32 v151, v158, v159
    s_waitcnt lgkmcnt(0)
    s_nop 1
    v_mfma_f32_32x32x16_bf16 v[40:55], v[120:123], v[144:147], v[40:55]
    v_mfma_f32_32x32x16_bf16 v[56:71], v[124:127], v[144:147], v[56:71]
    v_mfma_f32_32x32x16_bf16 v[72:87], v[128:131], v[144:147], v[72:87]
    v_mfma_f32_16x16x32_bf16 v[88:91], v[92:95], v[144:147], v[88:91]
    v_mfma_f32_32x32x16_bf16 v[40:55], v[132:135], v[148:151], v[40:55]
    v_mfma_f32_32x32x16_bf16 v[56:71], v[136:139], v[148:151], v[56:71]
    v_mfma_f32_32x32x16_bf16 v[72:87], v[140:143], v[148:151], v[72:87]
    v_mfma_f32_16x16x32_bf16 v[88:91], v[92:95], v[148:151], v[88:91]
    s_nop 15
    s_nop 15
    ds_read_b128 v[96:99], v4 offset:6144
    ds_read_b128 v[100:103], v5 offset:6144
    ds_read_b128 v[104:107], v4 offset:6208
    ds_read_b128 v[108:111], v5 offset:6208
    ds_read_b128 v[112:115], v4 offset:6272
    ds_read_b128 v[116:119], v5 offset:6272
    s_waitcnt lgkmcnt(0)
    ds_read_b64_tr_b16 v[120:121], v6 offset:6144
    ds_read_b64_tr_b16 v[122:123], v7 offset:6144
    ds_read_b64_tr_b16 v[124:125], v6 offset:6208
    ds_read_b64_tr_b16 v[126:127], v7 offset:6208
    ds_read_b64_tr_b16 v[128:129], v6 offset:6272
    ds_read_b64_tr_b16 v[130:131], v7 offset:6272
    ds_read_b64_tr_b16 v[132:133], v6 offset:9216
    ds_read_b64_tr_b16 v[134:135], v7 offset:9216
    ds_read_b64_tr_b16 v[136:137], v6 offset:9280
    ds_read_b64_tr_b16 v[138:139], v7 offset:9280
    ds_read_b64_tr_b16 v[140:141], v6 offset:9344
    ds_read_b64_tr_b16 v[142:143], v7 offset:9344
    v_mfma_f32_32x32x16_bf16 v[144:159], v[96:99], v[16:19], 0
    v_mfma_f32_32x32x16_bf16 v[144:159], v[100:103], v[20:23], v[144:159]
    v_mfma_f32_32x32x16_bf16 v[144:159], v[104:107], v[24:27], v[144:159]
    v_mfma_f32_32x32x16_bf16 v[144:159], v[108:111], v[28:31], v[144:159]
    v_mfma_f32_32x32x16_bf16 v[144:159], v[112:115], v[32:35], v[144:159]
    v_mfma_f32_32x32x16_bf16 v[144:159], v[116:119], v[36:39], v[144:159]
    s_nop 15
    s_nop 15
    v_max3_f32 v161, v144, v145, v146
    v_max3_f32 v161, v161, v147, v148
    v_max3_f32 v161, v161, v149, v150
    v_max3_f32 v161, v161, v151, v152
    v_max3_f32 v161, v161, v153, v154
    v_max3_f32 v161, v161, v155, v156
    v_max3_f32 v161, v161, v157, v158
    v_max_f32 v161, v161, v159
    v_mov_b32 v162, v161
    s_nop 1
    v_permlane32_swap_b32 v161, v162
    s_nop 1
    v_max_f32 v161, v161, v162
    v_max_f32 v161, v161, v160
    v_sub_f32 v164, v160, v161
    v_exp_f32 v164, v164
    v_mov_b32 v160, v161
    s_nop 1
    v_mov_b32 v165, v164
    v_mov_b32 v166, v164
    s_nop 1
    v_permlane16_swap_b32 v165, v166
    s_nop 1
    v_mul_f32 v40, v40, v164
    v_mul_f32 v41, v41, v164
    v_mul_f32 v42, v42, v164
    v_mul_f32 v43, v43, v164
    v_mul_f32 v44, v44, v164
    v_mul_f32 v45, v45, v164
    v_mul_f32 v46, v46, v164
    v_mul_f32 v47, v47, v164
    v_mul_f32 v48, v48, v164
    v_mul_f32 v49, v49, v164
    v_mul_f32 v50, v50, v164
    v_mul_f32 v51, v51, v164
    v_mul_f32 v52, v52, v164
    v_mul_f32 v53, v53, v164
    v_mul_f32 v54, v54, v164
    v_mul_f32 v55, v55, v164
    v_mul_f32 v56, v56, v164
    v_mul_f32 v57, v57, v164
    v_mul_f32 v58, v58, v164
    v_mul_f32 v59, v59, v164
    v_mul_f32 v60, v60, v164
    v_mul_f32 v61, v61, v164
    v_mul_f32 v62, v62, v164
    v_mul_f32 v63, v63, v164
    v_mul_f32 v64, v64, v164
    v_mul_f32 v65, v65, v164
    v_mul_f32 v66, v66, v164
    v_mul_f32 v67, v67, v164
    v_mul_f32 v68, v68, v164
    v_mul_f32 v69, v69, v164
    v_mul_f32 v70, v70, v164
    v_mul_f32 v71, v71, v164
    v_mul_f32 v72, v72, v164
    v_mul_f32 v73, v73, v164
    v_mul_f32 v74, v74, v164
    v_mul_f32 v75, v75, v164
    v_mul_f32 v76, v76, v164
    v_mul_f32 v77, v77, v164
    v_mul_f32 v78, v78, v164
    v_mul_f32 v79, v79, v164
    v_mul_f32 v80, v80, v164
    v_mul_f32 v81, v81, v164
    v_mul_f32 v82, v82, v164
    v_mul_f32 v83, v83, v164
    v_mul_f32 v84, v84, v164
    v_mul_f32 v85, v85, v164
    v_mul_f32 v86, v86, v164
    v_mul_f32 v87, v87, v164
    v_mul_f32 v88, v88, v165
    v_mul_f32 v89, v89, v166
    v_mul_f32 v90, v90, v165
    v_mul_f32 v91, v91, v166
    v_sub_f32 v144, v144, v160
    v_sub_f32 v145, v145, v160
    v_sub_f32 v146, v146, v160
    v_sub_f32 v147, v147, v160
    v_sub_f32 v148, v148, v160
    v_sub_f32 v149, v149, v160
    v_sub_f32 v150, v150, v160
    v_sub_f32 v151, v151, v160
    v_sub_f32 v152, v152, v160
    v_sub_f32 v153, v153, v160
    v_sub_f32 v154, v154, v160
    v_sub_f32 v155, v155, v160
    v_sub_f32 v156, v156, v160
    v_sub_f32 v157, v157, v160
    v_sub_f32 v158, v158, v160
    v_sub_f32 v159, v159, v160
    v_exp_f32 v144, v144
    v_exp_f32 v145, v145
    v_exp_f32 v146, v146
    v_exp_f32 v147, v147
    v_exp_f32 v148, v148
    v_exp_f32 v149, v149
    v_exp_f32 v150, v150
    v_exp_f32 v151, v151
    v_exp_f32 v152, v152
    v_exp_f32 v153, v153
    v_exp_f32 v154, v154
    v_exp_f32 v155, v155
    v_exp_f32 v156, v156
    v_exp_f32 v157, v157
    v_exp_f32 v158, v158
    v_exp_f32 v159, v159
    s_nop 1
    v_cvt_pk_bf16_f32 v144, v144, v145
    v_cvt_pk_bf16_f32 v145, v146, v147
    v_cvt_pk_bf16_f32 v146, v148, v149
    v_cvt_pk_bf16_f32 v147, v150, v151
    v_cvt_pk_bf16_f32 v148, v152, v153
    v_cvt_pk_bf16_f32 v149, v154, v155
    v_cvt_pk_bf16_f32 v150, v156, v157
    v_cvt_pk_bf16_f32 v151, v158, v159
    s_waitcnt lgkmcnt(0)
    s_nop 1
    v_mfma_f32_32x32x16_bf16 v[40:55], v[120:123], v[144:147], v[40:55]
    v_mfma_f32_32x32x16_bf16 v[56:71], v[124:127], v[144:147], v[56:71]
    v_mfma_f32_32x32x16_bf16 v[72:87], v[128:131], v[144:147], v[72:87]
    v_mfma_f32_16x16x32_bf16 v[88:91], v[92:95], v[144:147], v[88:91]
    v_mfma_f32_32x32x16_bf16 v[40:55], v[132:135], v[148:151], v[40:55]
    v_mfma_f32_32x32x16_bf16 v[56:71], v[136:139], v[148:151], v[56:71]
    v_mfma_f32_32x32x16_bf16 v[72:87], v[140:143], v[148:151], v[72:87]
    v_mfma_f32_16x16x32_bf16 v[88:91], v[92:95], v[148:151], v[88:91]
    s_nop 15
    s_nop 15
    v_add_u32 v4, 24576, v4
    v_add_u32 v5, 24576, v5
    v_add_u32 v6, 24576, v6
    v_add_u32 v7, 24576, v7
    s_add_u32 s43, s43, 1
    s_setpc_b64 s[60:61]
Z_comb:
    v_lshlrev_b32 v2, 4, v1
    s_mul_i32 s40, s2, 65536
    s_lshl_b32 s41, s3, 13
    s_add_u32 s40, s40, s41
    s_add_u32 s41, s40, 4096
    v_lshrrev_b32 v16, 4, v1
    v_bfe_u32 v28, v1, 2, 2
    v_and_b32 v19, 3, v1
    v_lshlrev_b32 v3, 11, v28
    v_lshl_add_u32 v4, v16, 3, v3
    v_lshl_add_u32 v3, v16, 9, v3
    v_lshl_add_u32 v3, v19, 7, v3
    s_lshl_b32 s42, s2, 13
    s_add_u32 s42, s42, 1179648
    s_lshl_b32 s52, s3, 8
    s_add_u32 s52, s52, s42
    v_and_b32 v6, 15, v1
    s_lshl_b32 s43, s3, 4
    v_add_u32 v6, s43, v6
    v_min_u32 v6, 95, v6
    s_mul_i32 s44, s2, 96
    v_add_u32 v6, s44, v6
    v_lshlrev_b32 v6, 1, v6
    global_load_ushort v7, v6, s[4:5]
    v_lshl_add_u32 v29, v16, 3, v28
    v_mul_u32_u24 v29, 192, v29
    v_lshl_add_u32 v29, v19, 3, v29
    s_lshl_b32 s45, s3, 5
    v_add_u32 v14, s45, v29
    v_and_b32 v28, 15, v1
    v_mul_u32_u24 v15, 384, v16
    v_lshl_add_u32 v15, v28, 4, v15
    s_mul_i32 s45, s3, 1536
    s_add_u32 s45, s45, 20480
    v_add_u32 v15, s45, v15
    v_and_b32 v29, 7, v1
    v_lshlrev_b32 v8, 2, v29
    s_mov_b32 s45, 0x75316240
    v_bfe_u32 v8, s45, v8, 4
    v_add_u32 v8, 48, v8
    v_cmp_lt_u32 vcc, 7, v28
    v_lshlrev_b32 v17, 6, v16
    s_nop 0
    v_cndmask_b32 v8, v29, v8, vcc
    v_lshl_add_u32 v8, v8, 3, v17
    v_add_u32 v8, 20480, v8
    s_lshl_b32 s45, s3, 8
    s_add_u32 s45, s45, 32768
    v_lshlrev_b32 v9, 2, v28
    v_mad_u32_u24 v9, v16, 48, v9
    v_mov_b32 v29, 192
    v_cmp_lt_u32 vcc, 11, v28
    v_lshlrev_b32 v10, 4, v16
    v_add_u32 v10, s45, v10
    v_cndmask_b32 v9, v9, v29, vcc
    v_add_u32 v9, s45, v9
    s_bfe_u32 s50, s47, 0xe0001
    s_and_b32 s51, s47, 0x8000
    s_or_b32 s50, s50, s51
    s_lshr_b32 s46, s47, 15
    s_and_b32 s46, s46, 0x8000
    s_bfe_u32 s51, s47, 0xe0010
    s_or_b32 s51, s51, s46
    s_mov_b32 s48, 0xaaaaaaaa
    s_mov_b32 s49, 0xaaaaaaaa
    v_mov_b32 v12, s50
    v_mov_b32 v13, s51
    v_cndmask_b32 v12, v12, v13, s[48:49]
    v_mov_b32 v20, 0
    v_mov_b32 v21, 0
    v_mov_b32 v22, 0
    v_mov_b32 v23, 0
    v_mov_b32 v24, 0
    v_mov_b32 v25, 0
    v_mov_b32 v26, 0
    v_mov_b32 v27, 0
Z_again:
Z_poll:
    buffer_load_dwordx4 v[32:35], v2, s[36:39], s40 offen offset:0 sc1
    buffer_load_dwordx4 v[36:39], v2, s[36:39], s40 offen offset:1024 sc1
    buffer_load_dwordx4 v[40:43], v2, s[36:39], s40 offen offset:2048 sc1
    buffer_load_dwordx4 v[44:47], v2, s[36:39], s40 offen offset:3072 sc1
    buffer_load_dwordx4 v[48:51], v2, s[36:39], s41 offen offset:0 sc1
    buffer_load_dwordx4 v[52:55], v2, s[36:39], s41 offen offset:1024 sc1
    buffer_load_dwordx4 v[56:59], v2, s[36:39], s41 offen offset:2048 sc1
    buffer_load_dwordx4 v[60:63], v2, s[36:39], s41 offen offset:3072 sc1
    buffer_load_dwordx4 v[64:67], v3, s[36:39], s42 offen offset:0 sc1
    buffer_load_dwordx4 v[68:71], v3, s[36:39], s42 offen offset:16 sc1
    buffer_load_dwordx4 v[72:75], v3, s[36:39], s42 offen offset:32 sc1
    buffer_load_dwordx4 v[76:79], v3, s[36:39], s42 offen offset:48 sc1
    buffer_load_dwordx4 v[80:83], v3, s[36:39], s42 offen offset:64 sc1
    buffer_load_dwordx4 v[84:87], v3, s[36:39], s42 offen offset:80 sc1
    buffer_load_dwordx4 v[88:91], v3, s[36:39], s42 offen offset:96 sc1
    buffer_load_dwordx4 v[92:95], v3, s[36:39], s42 offen offset:112 sc1
    buffer_load_dwordx2 v[96:97], v4, s[36:39], s52 offen offset:0 sc1
    buffer_load_dwordx2 v[98:99], v4, s[36:39], s52 offen offset:32 sc1
    buffer_load_dwordx2 v[100:101], v4, s[36:39], s52 offen offset:64 sc1
    buffer_load_dwordx2 v[102:103], v4, s[36:39], s52 offen offset:96 sc1
    buffer_load_dwordx2 v[104:105], v4, s[36:39], s52 offen offset:128 sc1
    buffer_load_dwordx2 v[106:107], v4, s[36:39], s52 offen offset:160 sc1
    buffer_load_dwordx2 v[108:109], v4, s[36:39], s52 offen offset:192 sc1
    buffer_load_dwordx2 v[110:111], v4, s[36:39], s52 offen offset:224 sc1
    s_waitcnt vmcnt(0)
    v_mov_b32 v28, 0
    v_xor_b32 v29, v12, v35
    v_and_b32 v29, 0xffff, v29
    v_or_b32 v28, v28, v29
    v_xor_b32 v29, v12, v39
    v_and_b32 v29, 0xffff, v29
    v_or_b32 v28, v28, v29
    v_xor_b32 v29, v12, v43
    v_and_b32 v29, 0xffff, v29
    v_or_b32 v28, v28, v29
    v_xor_b32 v29, v12, v47
    v_and_b32 v29, 0xffff, v29
    v_or_b32 v28, v28, v29
    v_xor_b32 v29, v12, v51
    v_and_b32 v29, 0xffff, v29
    v_or_b32 v28, v28, v29
    v_xor_b32 v29, v12, v55
    v_and_b32 v29, 0xffff, v29
    v_or_b32 v28, v28, v29
    v_xor_b32 v29, v12, v59
    v_and_b32 v29, 0xffff, v29
    v_or_b32 v28, v28, v29
    v_xor_b32 v29, v12, v63
    v_and_b32 v29, 0xffff, v29
    v_or_b32 v28, v28, v29
    v_xor_b32 v29, s47, v65
    v_or_b32 v28, v28, v29
    v_xor_b32 v29, s47, v67
    v_or_b32 v28, v28, v29
    v_xor_b32 v29, s47, v69
    v_or_b32 v28, v28, v29
    v_xor_b32 v29, s47, v71
    v_or_b32 v28, v28, v29
    v_xor_b32 v29, s47, v73
    v_or_b32 v28, v28, v29
    v_xor_b32 v29, s47, v75
    v_or_b32 v28, v28, v29
    v_xor_b32 v29, s47, v77
    v_or_b32 v28, v28, v29
    v_xor_b32 v29, s47, v79
    v_or_b32 v28, v28, v29
    v_xor_b32 v29, s47, v81
    v_or_b32 v28, v28, v29
    v_xor_b32 v29, s47, v83
    v_or_b32 v28, v28, v29
    v_xor_b32 v29, s47, v85
    v_or_b32 v28, v28, v29
    v_xor_b32 v29, s47, v87
    v_or_b32 v28, v28, v29
    v_xor_b32 v29, s47, v89
    v_or_b32 v28, v28, v29
    v_xor_b32 v29, s47, v91
    v_or_b32 v28, v28, v29
    v_xor_b32 v29, s47, v93
    v_or_b32 v28, v28, v29
    v_xor_b32 v29, s47, v95
    v_or_b32 v28, v28, v29
    v_xor_b32 v29, s47, v97
    v_or_b32 v28, v28, v29
    v_xor_b32 v29, s47, v99
    v_or_b32 v28, v28, v29
    v_xor_b32 v29, s47, v101
    v_or_b32 v28, v28, v29
    v_xor_b32 v29, s47, v103
    v_or_b32 v28, v28, v29
    v_xor_b32 v29, s47, v105
    v_or_b32 v28, v28, v29
    v_xor_b32 v29, s47, v107
    v_or_b32 v28, v28, v29
    v_xor_b32 v29, s47, v109
    v_or_b32 v28, v28, v29
    v_xor_b32 v29, s47, v111
    v_or_b32 v28, v28, v29
    v_cmp_ne_u32 vcc, 0, v28
    s_nop 4
    s_cbranch_vccnz Z_again
    v_max_f32 v64, v64, v66
    v_max_f32 v64, v64, v68
    v_max_f32 v64, v64, v70
    v_max_f32 v64, v64, v72
    v_max_f32 v64, v64, v74
    v_max_f32 v64, v64, v76
    v_max_f32 v64, v64, v78
    v_max_f32 v64, v64, v80
    v_max_f32 v64, v64, v82
    v_max_f32 v64, v64, v84
    v_max_f32 v64, v64, v86
    v_max_f32 v64, v64, v88
    v_max_f32 v64, v64, v90
    v_max_f32 v64, v64, v92
    v_max_f32 v64, v64, v94
    s_nop 1
    v_mov_b32_dpp v65, v64 quad_perm:[1,0,3,2] row_mask:0xf bank_mask:0xf
    v_max_f32 v64, v64, v65
    s_nop 1
    v_mov_b32_dpp v65, v64 quad_perm:[2,3,0,1] row_mask:0xf bank_mask:0xf
    v_max_f32 v64, v64, v65
    v_mov_b32 v28, v64
    s_nop 1
    v_permlane16_swap_b32 v64, v28
    s_nop 1
    v_max_f32 v64, v64, v28
    v_mov_b32 v28, v64
    s_nop 1
    v_permlane32_swap_b32 v64, v28
    s_nop 1
    v_max_f32 v64, v64, v28
    s_mov_b32 s46, 0xffff0000
    v_sub_f32 v96, v96, v64
    v_exp_f32 v96, v96
    s_nop 1
    v_lshlrev_b32 v28, 16, v32
    v_and_b32 v29, s46, v32
    v_fmac_f32 v20, v28, v96
    v_fmac_f32 v21, v29, v96
    v_lshlrev_b32 v28, 16, v33
    v_and_b32 v29, s46, v33
    v_fmac_f32 v22, v28, v96
    v_fmac_f32 v23, v29, v96
    v_lshlrev_b32 v28, 16, v34
    v_and_b32 v29, s46, v34
    v_fmac_f32 v24, v28, v96
    v_fmac_f32 v25, v29, v96
    v_lshlrev_b32 v28, 16, v35
    v_and_b32 v29, s46, v35
    v_fmac_f32 v27, v29, v96
    v_sub_f32 v98, v98, v64
    v_exp_f32 v98, v98
    s_nop 1
    v_lshlrev_b32 v28, 16, v36
    v_and_b32 v29, s46, v36
    v_fmac_f32 v20, v28, v98
    v_fmac_f32 v21, v29, v98
    v_lshlrev_b32 v28, 16, v37
    v_and_b32 v29, s46, v37
    v_fmac_f32 v22, v28, v98
    v_fmac_f32 v23, v29, v98
    v_lshlrev_b32 v28, 16, v38
    v_and_b32 v29, s46, v38
    v_fmac_f32 v24, v28, v98
    v_fmac_f32 v25, v29, v98
    v_lshlrev_b32 v28, 16, v39
    v_and_b32 v29, s46, v39
    v_fmac_f32 v27, v29, v98
    v_sub_f32 v100, v100, v64
    v_exp_f32 v100, v100
    s_nop 1
    v_lshlrev_b32 v28, 16, v40
    v_and_b32 v29, s46, v40
    v_fmac_f32 v20, v28, v100
    v_fmac_f32 v21, v29, v100
    v_lshlrev_b32 v28, 16, v41
    v_and_b32 v29, s46, v41
    v_fmac_f32 v22, v28, v100
    v_fmac_f32 v23, v29, v100
    v_lshlrev_b32 v28, 16, v42
    v_and_b32 v29, s46, v42
    v_fmac_f32 v24, v28, v100
    v_fmac_f32 v25, v29, v100
    v_lshlrev_b32 v28, 16, v43
    v_and_b32 v29, s46, v43
    v_fmac_f32 v27, v29, v100
    v_sub_f32 v102, v102, v64
    v_exp_f32 v102, v102
    s_nop 1
    v_lshlrev_b32 v28, 16, v44
    v_and_b32 v29, s46, v44
    v_fmac_f32 v20, v28, v102
    v_fmac_f32 v21, v29, v102
    v_lshlrev_b32 v28, 16, v45
    v_and_b32 v29, s46, v45
    v_fmac_f32 v22, v28, v102
    v_fmac_f32 v23, v29, v102
    v_lshlrev_b32 v28, 16, v46
    v_and_b32 v29, s46, v46
    v_fmac_f32 v24, v28, v102
    v_fmac_f32 v25, v29, v102
    v_lshlrev_b32 v28, 16, v47
    v_and_b32 v29, s46, v47
    v_fmac_f32 v27, v29, v102
    v_sub_f32 v104, v104, v64
    v_exp_f32 v104, v104
    s_nop 1
    v_lshlrev_b32 v28, 16, v48
    v_and_b32 v29, s46, v48
    v_fmac_f32 v20, v28, v104
    v_fmac_f32 v21, v29, v104
    v_lshlrev_b32 v28, 16, v49
    v_and_b32 v29, s46, v49
    v_fmac_f32 v22, v28, v104
    v_fmac_f32 v23, v29, v104
    v_lshlrev_b32 v28, 16, v50
    v_and_b32 v29, s46, v50
    v_fmac_f32 v24, v28, v104
    v_fmac_f32 v25, v29, v104
    v_lshlrev_b32 v28, 16, v51
    v_and_b32 v29, s46, v51
    v_fmac_f32 v27, v29, v104
    v_sub_f32 v106, v106, v64
    v_exp_f32 v106, v106
    s_nop 1
    v_lshlrev_b32 v28, 16, v52
    v_and_b32 v29, s46, v52
    v_fmac_f32 v20, v28, v106
    v_fmac_f32 v21, v29, v106
    v_lshlrev_b32 v28, 16, v53
    v_and_b32 v29, s46, v53
    v_fmac_f32 v22, v28, v106
    v_fmac_f32 v23, v29, v106
    v_lshlrev_b32 v28, 16, v54
    v_and_b32 v29, s46, v54
    v_fmac_f32 v24, v28, v106
    v_fmac_f32 v25, v29, v106
    v_lshlrev_b32 v28, 16, v55
    v_and_b32 v29, s46, v55
    v_fmac_f32 v27, v29, v106
    v_sub_f32 v108, v108, v64
    v_exp_f32 v108, v108
    s_nop 1
    v_lshlrev_b32 v28, 16, v56
    v_and_b32 v29, s46, v56
    v_fmac_f32 v20, v28, v108
    v_fmac_f32 v21, v29, v108
    v_lshlrev_b32 v28, 16, v57
    v_and_b32 v29, s46, v57
    v_fmac_f32 v22, v28, v108
    v_fmac_f32 v23, v29, v108
    v_lshlrev_b32 v28, 16, v58
    v_and_b32 v29, s46, v58
    v_fmac_f32 v24, v28, v108
    v_fmac_f32 v25, v29, v108
    v_lshlrev_b32 v28, 16, v59
    v_and_b32 v29, s46, v59
    v_fmac_f32 v27, v29, v108
    v_sub_f32 v110, v110, v64
    v_exp_f32 v110, v110
    s_nop 1
    v_lshlrev_b32 v28, 16, v60
    v_and_b32 v29, s46, v60
    v_fmac_f32 v20, v28, v110
    v_fmac_f32 v21, v29, v110
    v_lshlrev_b32 v28, 16, v61
    v_and_b32 v29, s46, v61
    v_fmac_f32 v22, v28, v110
    v_fmac_f32 v23, v29, v110
    v_lshlrev_b32 v28, 16, v62
    v_and_b32 v29, s46, v62
    v_fmac_f32 v24, v28, v110
    v_fmac_f32 v25, v29, v110
    v_lshlrev_b32 v28, 16, v63
    v_and_b32 v29, s46, v63
    v_fmac_f32 v27, v29, v110
    v_mov_b32 v28, v20
    s_nop 1
    v_permlane16_swap_b32 v20, v28
    s_nop 1
    v_add_f32 v20, v20, v28
    v_mov_b32 v28, v20
    s_nop 1
    v_permlane32_swap_b32 v20, v28
    s_nop 1
    v_add_f32 v20, v20, v28
    v_mov_b32 v28, v21
    s_nop 1
    v_permlane16_swap_b32 v21, v28
    s_nop 1
    v_add_f32 v21, v21, v28
    v_mov_b32 v28, v21
    s_nop 1
    v_permlane32_swap_b32 v21, v28
    s_nop 1
    v_add_f32 v21, v21, v28
    v_mov_b32 v28, v22
    s_nop 1
    v_permlane16_swap_b32 v22, v28
    s_nop 1
    v_add_f32 v22, v22, v28
    v_mov_b32 v28, v22
    s_nop 1
    v_permlane32_swap_b32 v22, v28
    s_nop 1
    v_add_f32 v22, v22, v28
    v_mov_b32 v28, v23
    s_nop 1
    v_permlane16_swap_b32 v23, v28
    s_nop 1
    v_add_f32 v23, v23, v28
    v_mov_b32 v28, v23
    s_nop 1
    v_permlane32_swap_b32 v23, v28
    s_nop 1
    v_add_f32 v23, v23, v28
    v_mov_b32 v28, v24
    s_nop 1
    v_permlane16_swap_b32 v24, v28
    s_nop 1
    v_add_f32 v24, v24, v28
    v_mov_b32 v28, v24
    s_nop 1
    v_permlane32_swap_b32 v24, v28
    s_nop 1
    v_add_f32 v24, v24, v28
    v_mov_b32 v28, v25
    s_nop 1
    v_permlane16_swap_b32 v25, v28
    s_nop 1
    v_add_f32 v25, v25, v28
    v_mov_b32 v28, v25
    s_nop 1
    v_permlane32_swap_b32 v25, v28
    s_nop 1
    v_add_f32 v25, v25, v28
    v_mov_b32 v28, v26
    s_nop 1
    v_permlane16_swap_b32 v26, v28
    s_nop 1
    v_add_f32 v26, v26, v28
    v_mov_b32 v28, v26
    s_nop 1
    v_permlane32_swap_b32 v26, v28
    s_nop 1
    v_add_f32 v26, v26, v28
    v_mov_b32 v28, v27
    s_nop 1
    v_permlane16_swap_b32 v27, v28
    s_nop 1
    v_add_f32 v27, v27, v28
    v_mov_b32 v28, v27
    s_nop 1
    v_permlane32_swap_b32 v27, v28
    s_nop 1
    v_add_f32 v27, v27, v28
    v_cmp_eq_u32 vcc, 0, v16
    s_nop 1
    v_cndmask_b32 v20, v24, v20, vcc
    v_cndmask_b32 v21, v25, v21, vcc
    v_cndmask_b32 v22, v26, v22, vcc
    v_cndmask_b32 v23, v27, v23, vcc
    s_nop 1
    s_branch K_red
.section .rodata,"a"
.p2align 6
.amdhsa_kernel standalone__detection_seg_mask2former__vision_kernel
  .amdhsa_next_free_vgpr 256
  .amdhsa_next_free_sgpr 100
  .amdhsa_accum_offset 256
  .amdhsa_group_segment_fixed_size 0
  .amdhsa_kernarg_size 96
  .amdhsa_user_sgpr_count 2
  .amdhsa_user_sgpr_kernarg_segment_ptr 1
  .amdhsa_system_sgpr_workgroup_id_x 1
.end_amdhsa_kernel
```
